```python
import torch

def _softmax(x, axis=-1):
    return torch.softmax(x, dim=axis)
def _gelu(x):
    return torch.nn.functional.gelu(x, approximate="tanh")
def _silu(x):
    return torch.nn.functional.silu(x)
def _sigmoid(x):
    return torch.sigmoid(x)
def _layernorm(x, axis=-1, eps=1e-5):
    m = x.mean(dim=axis, keepdim=True)
    v = x.var(dim=axis, keepdim=True, unbiased=False)
    return (x - m) / torch.sqrt(v + eps)
def _scatter_add(tgt, idx, src, axis=0):
    return tgt.clone().index_add_(axis, idx, src)
def _segment_sum(src, seg, n):
    out = torch.zeros((n,) + src.shape[1:], dtype=src.dtype)
    return out.index_add_(0, seg, src)
def _pad(x, pw):
    flat = tuple(v for pair in reversed(pw) for v in pair)
    return torch.nn.functional.pad(x, flat)

kernel_name = 'standalone__self_sup_conv_stem_hubert__speech'

def setup_inputs():

    _w = (lambda a: (lambda t: t.to(torch.bfloat16) if t.is_floating_point() else t)(torch.as_tensor(a)))
    B, T, D, K = 2, 16000, 256, 31
    scale = (1.0 / (K * D)) ** 0.5
    return {
        "x": _w((lambda *s: torch.randn(*s, dtype=torch.bfloat16) * 0.05)(B, T, D)),
        "w": _w((lambda *s: torch.randn(*s, dtype=torch.bfloat16) * 0.05)(K, D, D) * scale),
        "b": _w((lambda *s: torch.randn(*s, dtype=torch.bfloat16) * 0.05)(D) * 0.1),
        "gamma": _w(torch.ones((D,), dtype=float)),
        "beta": _w(torch.zeros((D,), dtype=float)),
    }

def reference(x, w, b, gamma, beta):
    B, T, D = x.shape
    K = w.shape[0]
    s = 2
    L = (T - K) // s + 1
    y = torch.einsum('blc,cd->bld', x[:, 0 : s * L : s, :], w[0])
    for i in range(1, K):
        y = y + torch.einsum('blc,cd->bld', x[:, i : i + s * L : s, :], w[i])
    y = y + b[None, None, :]
    mu = y.mean(1, keepdims=True)
    var = ((y - mu) ** 2).mean(1, keepdims=True)
    yn = (y - mu) / torch.sqrt(var + 1e-5)
    yn = yn * gamma[None, None, :] + beta[None, None, :]
    return _gelu(yn)
```

```asm
; @launch grid=(256,1,1) block=(256,1,1) lds=161792
.amdgcn_target "amdgcn-amd-amdhsa--gfx950"
.text
.globl standalone__self_sup_conv_stem_hubert__speech_kernel
.p2align 8
.type standalone__self_sup_conv_stem_hubert__speech_kernel,@function
standalone__self_sup_conv_stem_hubert__speech_kernel:
    s_cmp_ge_u32 s2, 256
    s_cbranch_scc1 L_end
    s_load_dwordx16 s[16:31], s[0:1], 0
    s_getpc_b64 s[96:97]
L_pc:
    s_mov_b32 s98, L_codeend - L_pc
    s_mov_b32 s99, 0x20000
    s_bfe_u32 s50, s2, 0x30003
    s_lshl_b32 s50, s50, 12
    v_lshrrev_b32 v13, 6, v0
    v_and_b32 v14, 7, v0
    v_lshlrev_b32 v14, 7, v14
    v_lshl_add_u32 v14, v13, 10, v14
    buffer_load_dword v147, v14, s[96:99], s50 offen
    v_lshrrev_b32 v13, 6, v0
    v_and_b32 v1, 63, v0
    s_and_b32 s36, s2, 1
    v_readfirstlane_b32 s39, v13
    s_bfe_u32 s37, s2, 0x20003
    s_bfe_u32 s38, s2, 0x20001
    s_lshr_b32 s48, s2, 5
    s_lshl_b32 s38, s38, 3
    s_add_u32 s38, s38, s48
    v_lshlrev_b32 v2, 4, v1
    s_lshl_b32 s40, s37, 2
    s_add_u32 s40, s40, s39
    v_lshrrev_b32 v13, 3, v0
    v_bfe_u32 v14, v0, 4, 1
    v_bfe_u32 v15, v0, 6, 1
    v_lshl_add_u32 v14, v15, 1, v14
    v_bfe_u32 v15, v0, 1, 2
    v_xor_b32 v14, v14, v15
    v_lshlrev_b32 v14, 5, v14
    v_lshl_add_u32 v14, v13, 9, v14
    v_and_b32 v15, 1, v0
    v_lshl_add_u32 v14, v15, 4, v14
    s_lshl_b32 s48, s37, 7
    v_add_u32 v14, s48, v14
    s_lshl_b32 s48, s40, 5
    s_and_b32 s3, s38, 7
    s_lshl_b32 s3, s3, 2
    s_lshr_b32 s50, s38, 3
    s_add_u32 s3, s3, s50
    s_lshl_b32 s3, s3, 1
    s_add_u32 s3, s3, s36
    s_lshr_b32 s50, s3, 2
    s_add_u32 s50, s50, 1
    s_and_b32 s50, s50, 15
    s_and_b32 s51, s3, 3
    s_and_b32 s52, s50, 1
    s_lshl_b32 s49, s51, 3
    s_add_u32 s49, s49, s52
    s_lshl_b32 s49, s49, 17
    s_lshr_b32 s52, s50, 1
    s_lshl_b32 s52, s52, 14
    s_add_u32 s49, s49, s52
    s_mul_i32 s53, s50, 24576
    s_lshl_b32 s52, s51, 11
    s_add_u32 s53, s53, s52
    s_lshl_b32 s47, s39, 10
    s_mov_b32 s10, 4063232
    s_mov_b32 s11, 0x20000
    s_mov_b32 s6, 16384000
    s_mov_b32 s7, 0x20000
    s_mul_i32 s55, s38, 261120
    s_mul_i32 s56, s36, 8192000
    s_add_u32 s55, s55, s56
    s_lshl_b32 s56, s39, 4
    s_movk_i32 s57, 241
    v_lshrrev_b32 v152, 2, v1
    v_add_u32 v152, s56, v152
    v_and_b32 v153, 3, v1
    v_add_u32 v13, 0, v152
    v_cmp_le_u32 vcc, 136, v13
    v_subrev_u32 v15, 136, v13
    s_nop 0
    v_cndmask_b32 v13, v13, v15, vcc
    v_cndmask_b32 v150, 0, 2, vcc
    v_mul_u32_u24 v15, s57, v13
    v_lshrrev_b32 v15, 12, v15
    v_mul_u32_u24 v151, 17, v15
    v_sub_u32 v13, v13, v151
    v_lshl_add_u32 v15, v13, 3, v15
    v_lshl_add_u32 v15, v15, 2, v150
    v_lshlrev_b32 v15, 9, v15
    v_lshrrev_b32 v13, 1, v13
    v_and_b32 v13, 2, v13
    v_xor_b32 v13, v13, v153
    v_lshl_add_u32 v15, v13, 4, v15
    v_add_u32 v8, s55, v15
    v_add_u32 v13, 64, v152
    v_cmp_le_u32 vcc, 136, v13
    v_subrev_u32 v15, 136, v13
    s_nop 0
    v_cndmask_b32 v13, v13, v15, vcc
    v_cndmask_b32 v150, 0, 2, vcc
    v_mul_u32_u24 v15, s57, v13
    v_lshrrev_b32 v15, 12, v15
    v_mul_u32_u24 v151, 17, v15
    v_sub_u32 v13, v13, v151
    v_lshl_add_u32 v15, v13, 3, v15
    v_lshl_add_u32 v15, v15, 2, v150
    v_lshlrev_b32 v15, 9, v15
    v_lshrrev_b32 v13, 1, v13
    v_and_b32 v13, 2, v13
    v_xor_b32 v13, v13, v153
    v_lshl_add_u32 v15, v13, 4, v15
    v_add_u32 v9, s55, v15
    v_add_u32 v13, 128, v152
    v_cmp_le_u32 vcc, 136, v13
    v_subrev_u32 v15, 136, v13
    s_nop 0
    v_cndmask_b32 v13, v13, v15, vcc
    v_cndmask_b32 v150, 0, 2, vcc
    v_mul_u32_u24 v15, s57, v13
    v_lshrrev_b32 v15, 12, v15
    v_mul_u32_u24 v151, 17, v15
    v_sub_u32 v13, v13, v151
    v_lshl_add_u32 v15, v13, 3, v15
    v_lshl_add_u32 v15, v15, 2, v150
    v_lshlrev_b32 v15, 9, v15
    v_lshrrev_b32 v13, 1, v13
    v_and_b32 v13, 2, v13
    v_xor_b32 v13, v13, v153
    v_lshl_add_u32 v15, v13, 4, v15
    v_add_u32 v10, s55, v15
    v_add_u32 v13, 192, v152
    v_cmp_le_u32 vcc, 136, v13
    v_subrev_u32 v15, 136, v13
    s_nop 0
    v_cndmask_b32 v13, v13, v15, vcc
    v_cndmask_b32 v150, 0, 2, vcc
    v_mul_u32_u24 v15, s57, v13
    v_lshrrev_b32 v15, 12, v15
    v_mul_u32_u24 v151, 17, v15
    v_sub_u32 v13, v13, v151
    v_lshl_add_u32 v15, v13, 3, v15
    v_lshl_add_u32 v15, v15, 2, v150
    v_lshlrev_b32 v15, 9, v15
    v_lshrrev_b32 v13, 1, v13
    v_and_b32 v13, 2, v13
    v_xor_b32 v13, v13, v153
    v_lshl_add_u32 v15, v13, 4, v15
    v_add_u32 v11, s55, v15
    s_lshl_b32 s56, s39, 2
    s_add_u32 s56, s56, 256
    v_lshrrev_b32 v13, 4, v1
    v_add_u32 v13, s56, v13
    v_bfe_u32 v153, v1, 2, 2
    v_cmp_le_u32 vcc, 136, v13
    v_subrev_u32 v15, 136, v13
    s_nop 0
    v_cndmask_b32 v13, v13, v15, vcc
    v_cndmask_b32 v150, 0, 2, vcc
    v_mul_u32_u24 v15, s57, v13
    v_lshrrev_b32 v15, 12, v15
    v_mul_u32_u24 v151, 17, v15
    v_sub_u32 v13, v13, v151
    v_lshl_add_u32 v15, v13, 3, v15
    v_lshl_add_u32 v15, v15, 2, v150
    v_lshlrev_b32 v15, 9, v15
    v_lshrrev_b32 v13, 1, v13
    v_and_b32 v13, 2, v13
    v_xor_b32 v13, v13, v153
    v_lshl_add_u32 v15, v13, 4, v15
    v_add_u32 v12, s55, v15
    v_and_b32 v13, 3, v1
    v_lshl_add_u32 v12, v13, 2, v12
    s_lshl_b32 s58, s39, 8
    s_add_u32 s58, s58, 16384
    s_mov_b32 s45, 0
    s_movk_i32 s60, 512
    s_add_u32 s62, s47, 100352
    s_add_u32 s63, s47, 52224
    s_mov_b32 s64, 524288
    s_mov_b32 s65, 1048576
    s_mov_b32 s66, 1572864
    s_mov_b32 s67, 2097152
    s_mov_b32 s68, 2621440
    s_mov_b32 s69, 3145728
    s_mov_b32 s61, 3670016
    s_and_b32 s50, s38, 7
    s_lshl_b32 s50, s50, 2
    s_add_u32 s50, s50, s39
    s_lshr_b32 s51, s50, 1
    s_lshl_b32 s51, s51, 18
    s_and_b32 s52, s50, 1
    s_lshl_b32 s52, s52, 13
    s_add_u32 s51, s51, s52
    s_add_u32 s51, s51, 131072
    s_lshr_b32 s52, s50, 2
    s_lshl_b32 s52, s52, 19
    s_and_b32 s50, s50, 3
    s_lshl_b32 s50, s50, 12
    s_add_u32 s50, s50, s52
    s_add_u32 s50, s50, 262144
    v_and_b32 v13, 15, v1
    v_lshl_add_u32 v150, v13, 9, s51
    v_and_b32 v13, 7, v1
    v_lshl_add_u32 v13, v13, 9, s50
    v_cmp_gt_u32 vcc, 16, v1
    s_lshl_b32 s54, s37, 7
    s_movk_i32 s59, 512
    v_cndmask_b32 v150, v13, v150, vcc
    s_cmp_eq_u32 s37, 1
    s_cselect_b64 vcc, -1, 0
    v_cndmask_b32 v151, v8, v9, vcc
    s_cmp_eq_u32 s37, 2
    s_cselect_b64 vcc, -1, 0
    v_cndmask_b32 v151, v151, v10, vcc
    s_cmp_eq_u32 s37, 3
    s_cselect_b64 vcc, -1, 0
    v_cndmask_b32 v151, v151, v11, vcc
    v_mov_b32 v252, v14
    s_lshl_b32 s52, s37, 8
    s_add_u32 s52, s52, 2097152
    s_waitcnt lgkmcnt(0)
    s_mov_b32 s8, s18
    s_mov_b32 s9, s19
    s_mov_b32 s4, s16
    s_mov_b32 s5, s17
    s_add_u32 m0, s47, 0
    s_nop 0
    buffer_load_dwordx4 v8, s[4:7], s45 offen lds
    s_add_u32 m0, s47, 4096
    s_nop 0
    buffer_load_dwordx4 v9, s[4:7], s45 offen lds
    s_add_u32 m0, s47, 8192
    s_nop 0
    buffer_load_dwordx4 v10, s[4:7], s45 offen lds
    s_add_u32 m0, s47, 12288
    s_nop 0
    buffer_load_dwordx4 v11, s[4:7], s45 offen lds
    s_add_u32 m0, s58, 0
    s_nop 0
    buffer_load_dword v12, s[4:7], s45 offen lds
    s_add_u32 s32, s30, 8388608
    s_addc_u32 s33, s31, 0
    s_load_dword s43, s[32:33], s52
    s_add_u32 m0, s62, 0
    s_nop 0
    buffer_load_dwordx4 v252, s[8:11], 0 offen lds
    s_add_u32 m0, s62, 4096
    s_nop 0
    buffer_load_dwordx4 v252, s[8:11], s64 offen lds
    s_add_u32 m0, s62, 8192
    s_nop 0
    buffer_load_dwordx4 v252, s[8:11], s65 offen lds
    s_add_u32 m0, s62, 12288
    s_nop 0
    buffer_load_dwordx4 v252, s[8:11], s66 offen lds
    s_add_u32 m0, s62, 16384
    s_nop 0
    buffer_load_dwordx4 v252, s[8:11], s67 offen lds
    s_add_u32 m0, s62, 20480
    s_nop 0
    buffer_load_dwordx4 v252, s[8:11], s68 offen lds
    s_add_u32 m0, s62, 24576
    s_nop 0
    buffer_load_dwordx4 v252, s[8:11], s69 offen lds
    s_add_u32 m0, s62, 28672
    s_nop 0
    buffer_load_dwordx4 v252, s[8:11], s61 offen lds
    buffer_load_dword v147, v150, s[8:11], s54 offen
    buffer_load_dword v147, v151, s[4:7], s59 offen
    s_add_u32 m0, s47, 82944
    s_nop 0
    buffer_load_dwordx4 v14, s[8:11], s49 offen lds
    s_add_u32 s49, s49, 262144
    s_add_u32 m0, s47, 87040
    s_nop 0
    buffer_load_dwordx4 v14, s[8:11], s49 offen lds
    s_add_u32 s49, s49, 262144
    s_add_u32 m0, s47, 91136
    s_nop 0
    buffer_load_dwordx4 v14, s[8:11], s49 offen lds
    s_add_u32 s49, s49, 262144
    s_add_u32 m0, s47, 95232
    s_nop 0
    buffer_load_dwordx4 v14, s[8:11], s49 offen lds
    v_add_u32 v252, 262144, v14
    v_and_b32 v13, 15, v1
    v_lshrrev_b32 v15, 4, v1
    v_lshrrev_b32 v150, 1, v13
    v_and_b32 v150, 2, v150
    v_xor_b32 v150, v150, v15
    v_lshlrev_b32 v150, 4, v150
    v_lshl_add_u32 v3, v13, 6, v150
    v_add_u32 v13, 1, v13
    v_lshrrev_b32 v150, 1, v13
    v_and_b32 v150, 2, v150
    v_xor_b32 v150, v150, v15
    v_lshlrev_b32 v150, 4, v150
    v_lshl_add_u32 v4, v13, 6, v150
    s_mul_i32 s52, s39, 2176
    v_add_u32 v5, s52, v2
    v_add_u32 v6, 2176, v5
    v_lshrrev_b32 v13, 2, v1
    v_add_u32 v15, 1, v13
    v_xor_b32 v13, v13, v15
    v_lshrrev_b32 v13, 1, v13
    v_and_b32 v13, 2, v13
    v_and_b32 v150, 3, v1
    v_xor_b32 v13, v13, v150
    v_lshlrev_b32 v13, 4, v13
    v_lshl_add_u32 v13, v15, 6, v13
    s_cmp_eq_u32 s39, 3
    s_cselect_b64 vcc, -1, 0
    v_cndmask_b32 v6, v6, v13, vcc
    v_bfe_u32 v13, v1, 4, 1
    v_mul_u32_u24 v13, 1088, v13
    v_and_b32 v15, 15, v1
    v_lshl_add_u32 v13, v15, 2, v13
    s_add_u32 s52, s52, 1024
    v_add_u32 v7, s52, v13
    v_mov_b32 v184, v3
    v_mov_b32 v185, v4
    v_mov_b32 v186, v5
    v_mov_b32 v187, v7
    v_bfe_u32 v13, v1, 3, 2
    v_xor_b32 v13, s39, v13
    v_lshlrev_b32 v13, 5, v13
    v_and_b32 v15, 3, v1
    v_lshl_add_u32 v13, v15, 3, v13
    v_bfe_u32 v15, v1, 2, 2
    v_lshl_add_u32 v13, v15, 7, v13
    v_lshrrev_b32 v15, 4, v1
    v_lshl_add_u32 v13, v15, 10, v13
    v_add_u32 v253, 100352, v13
    v_add_u32 v254, 52224, v13
    v_add_u32 v14, 82944, v13
    s_mul_i32 s52, s40, 393216
    s_add_u32 s12, s30, s52
    s_addc_u32 s13, s31, 0
    s_mov_b32 s14, 393216
    s_mov_b32 s15, 0x20000
    s_mov_b32 s34, 4194304
    s_mov_b32 s35, 0x20000
    s_add_u32 s48, s48, 0
    v_lshrrev_b32 v13, 4, v1
    v_lshlrev_b32 v13, 3, v13
    v_and_b32 v15, 3, v1
    v_lshl_add_u32 v13, v15, 1, v13
    v_add_u32 v13, s48, v13
    s_mov_b32 s55, s53
    s_mov_b32 s98, 40960
    s_mov_b32 s99, 45056
    s_add_u32 s48, s53, 8192
    s_add_u32 s49, s53, 16384
    s_waitcnt lgkmcnt(0)
    s_add_u32 s41, s43, 1
    s_mul_i32 s42, s43, 0x9E3779B1
    s_add_u32 s42, s42, 0x7F4A7C15
    s_xor_b32 s47, s47, 65536
    s_xor_b32 s58, s58, 65536
    s_add_u32 s45, s45, 64
    s_add_u32 s60, s45, 512
    s_lshl_b32 s52, s3, 3
    s_lshl_b32 s53, s40, 9
    s_add_u32 s52, s52, s53
    v_mov_b32 v150, s41
    v_mov_b32 v151, s42
    v_mov_b32 v148, s52
    s_mov_b64 s[56:57], 1
    v_lshl_add_u32 v149, v1, 3, s53
    s_mov_b64 exec, 0
    s_cmp_eq_u32 s39, 0
    s_cbranch_scc1 L_pg0
    s_cmp_eq_u32 s39, 1
    s_cbranch_scc1 L_pg1
    s_cmp_eq_u32 s39, 2
    s_cbranch_scc1 L_pg2
    s_branch L_pg3
.p2align 12
L_tret:
    s_mov_b64 exec, -1
    s_waitcnt vmcnt(6)
    s_barrier
    s_add_u32 m0, s62, 32768
    ds_read_b64_tr_b16 v[188:189], v253 offset:0
    buffer_load_dwordx4 v252, s[8:11], 0 offen lds
    ds_read_b64_tr_b16 v[190:191], v253 offset:512
    ds_read_b128 a[0:3], v184 offset:0
    s_add_u32 m0, s62, 36864
    ds_read_b128 a[4:7], v184 offset:1088
    buffer_load_dwordx4 v252, s[8:11], s64 offen lds
    ds_read_b64_tr_b16 v[192:193], v253 offset:4096
    ds_read_b64_tr_b16 v[194:195], v253 offset:4608
    s_add_u32 m0, s62, 40960
    ds_read_b128 a[8:11], v184 offset:2176
    buffer_load_dwordx4 v252, s[8:11], s65 offen lds
    ds_read_b128 a[12:15], v184 offset:3264
    ds_read_b128 a[16:19], v184 offset:4352
    s_add_u32 m0, s62, 45056
    ds_read_b128 a[20:23], v184 offset:5440
    buffer_load_dwordx4 v252, s[8:11], s66 offen lds
    ds_read_b128 a[24:27], v184 offset:6528
    ds_read_b128 a[28:31], v184 offset:7616
    ds_read_b128 a[32:35], v185 offset:0
    s_mov_b32 s44, 49152
    s_mov_b32 s46, 7
    s_waitcnt lgkmcnt(0)
    v_mfma_f32_16x16x32_bf16 v[16:19], v[188:191], a[0:3], 0
    s_add_u32 m0, s62, 49152
    ds_read_b64_tr_b16 v[196:197], v253 offset:8192
    ds_read_b64_tr_b16 v[198:199], v253 offset:8704
    v_mfma_f32_16x16x32_bf16 v[16:19], v[192:195], a[4:7], v[16:19]
    buffer_load_dwordx4 v252, s[8:11], s67 offen lds
    ds_read_b64_tr_b16 v[200:201], v253 offset:12288
    v_mfma_f32_16x16x32_bf16 v[20:23], v[188:191], a[4:7], 0
    ds_read_b64_tr_b16 v[202:203], v253 offset:12800
    ds_read_b128 a[36:39], v185 offset:1088
    v_mfma_f32_16x16x32_bf16 v[20:23], v[192:195], a[8:11], v[20:23]
    s_add_u32 m0, s62, 53248
    ds_read_b128 a[40:43], v185 offset:2176
    v_mfma_f32_16x16x32_bf16 v[24:27], v[188:191], a[8:11], 0
    buffer_load_dwordx4 v252, s[8:11], s68 offen lds
    v_mfma_f32_16x16x32_bf16 v[24:27], v[192:195], a[12:15], v[24:27]
    ds_read_b128 v[160:163], v186 offset:8704
    v_mfma_f32_16x16x32_bf16 v[28:31], v[188:191], a[12:15], 0
    s_add_u32 m0, s62, 57344
    ds_read_b128 v[164:167], v186 offset:1088
    v_mfma_f32_16x16x32_bf16 v[28:31], v[192:195], a[16:19], v[28:31]
    buffer_load_dwordx4 v252, s[8:11], s69 offen lds
    v_mfma_f32_16x16x32_bf16 v[32:35], v[188:191], a[16:19], 0
    ds_read_b64_tr_b16 v[204:205], v253 offset:16384
    ds_read_b64_tr_b16 v[206:207], v253 offset:16896
    v_mfma_f32_16x16x32_bf16 v[32:35], v[192:195], a[20:23], v[32:35]
    s_mov_b32 m0, s63
    ds_read_b64_tr_b16 v[208:209], v253 offset:20480
    ds_read_b64_tr_b16 v[210:211], v253 offset:20992
    v_mfma_f32_16x16x32_bf16 v[36:39], v[188:191], a[20:23], 0
    buffer_load_dwordx4 v252, s[8:11], s61 offen lds
    v_mfma_f32_16x16x32_bf16 v[36:39], v[192:195], a[24:27], v[36:39]
    s_waitcnt vmcnt(8)
    s_barrier
    ds_read_b128 a[44:47], v185 offset:3264
    v_mfma_f32_16x16x32_bf16 v[40:43], v[188:191], a[24:27], 0
    s_waitcnt lgkmcnt(5)
    v_lshlrev_b32 v172, 16, v160
    v_lshlrev_b32 v173, 16, v164
    v_mfma_f32_16x16x32_bf16 v[40:43], v[192:195], a[28:31], v[40:43]
    s_sub_u32 m0, s47, 48128
    v_and_b32 v174, 0xffff0000, v160
    v_and_b32 v175, 0xffff0000, v164
    v_mfma_f32_16x16x32_bf16 v[44:47], v[188:191], a[28:31], 0
    buffer_load_dwordx4 v8, s[4:7], s59 offen lds
    ds_read_b128 a[48:51], v185 offset:4352
    v_mfma_f32_16x16x32_bf16 v[44:47], v[192:195], a[32:35], v[44:47]
    s_waitcnt lgkmcnt(8)
    v_add_f32 v172, v172, v173
    v_add_f32 v174, v174, v175
    v_mfma_f32_16x16x32_bf16 v[16:19], v[196:199], a[8:11], v[16:19]
    v_subrev_u32 v252, 131072, v252
    v_cvt_pk_bf16_f32 v168, v172, v174
    v_lshlrev_b32 v172, 16, v161
    v_mfma_f32_16x16x32_bf16 v[16:19], v[200:203], a[12:15], v[16:19]
    s_sub_u32 m0, s47, 44032
    v_lshlrev_b32 v173, 16, v165
    ds_read_b64_tr_b16 v[212:213], v253 offset:24576
    v_mfma_f32_16x16x32_bf16 v[20:23], v[196:199], a[12:15], v[20:23]
    buffer_load_dwordx4 v9, s[4:7], s59 offen lds
    v_and_b32 v174, 0xffff0000, v161
    v_mfma_f32_16x16x32_bf16 v[20:23], v[200:203], a[16:19], v[20:23]
    ds_read_b64_tr_b16 v[214:215], v253 offset:25088
    v_and_b32 v175, 0xffff0000, v165
    ds_read_b64_tr_b16 v[216:217], v253 offset:28672
    v_mfma_f32_16x16x32_bf16 v[24:27], v[196:199], a[16:19], v[24:27]
    v_add_f32 v172, v172, v173
    ds_read_b64_tr_b16 v[218:219], v253 offset:29184
    v_add_f32 v174, v174, v175
    v_mfma_f32_16x16x32_bf16 v[24:27], v[200:203], a[20:23], v[24:27]
    s_sub_u32 m0, s47, 39936
    ds_read_b128 a[52:55], v185 offset:5440
    v_cvt_pk_bf16_f32 v169, v172, v174
    v_mfma_f32_16x16x32_bf16 v[28:31], v[196:199], a[20:23], v[28:31]
    buffer_load_dwordx4 v10, s[4:7], s59 offen lds
    ds_read_b128 a[56:59], v185 offset:6528
    v_mfma_f32_16x16x32_bf16 v[28:31], v[200:203], a[24:27], v[28:31]
    v_lshlrev_b32 v172, 16, v162
    v_lshlrev_b32 v173, 16, v166
    v_and_b32 v174, 0xffff0000, v162
    v_mfma_f32_16x16x32_bf16 v[32:35], v[196:199], a[24:27], v[32:35]
    v_and_b32 v175, 0xffff0000, v166
    v_add_f32 v172, v172, v173
    ds_read_b64_tr_b16 v[80:81], v14 offset:0
    v_mfma_f32_16x16x32_bf16 v[32:35], v[200:203], a[28:31], v[32:35]
    s_sub_u32 m0, s47, 35840
    v_add_f32 v174, v174, v175
    ds_read_b64_tr_b16 v[82:83], v14 offset:512
    v_mfma_f32_16x16x32_bf16 v[36:39], v[196:199], a[28:31], v[36:39]
    buffer_load_dwordx4 v11, s[4:7], s59 offen lds
    v_cvt_pk_bf16_f32 v170, v172, v174
    v_mfma_f32_16x16x32_bf16 v[36:39], v[200:203], a[32:35], v[36:39]
    v_lshlrev_b32 v172, 16, v163
    v_lshlrev_b32 v173, 16, v167
    v_and_b32 v174, 0xffff0000, v163
    v_mfma_f32_16x16x32_bf16 v[40:43], v[196:199], a[32:35], v[40:43]
    v_and_b32 v175, 0xffff0000, v167
    ds_read_b64_tr_b16 v[84:85], v14 offset:4096
    v_add_f32 v172, v172, v173
    v_mfma_f32_16x16x32_bf16 v[40:43], v[200:203], a[36:39], v[40:43]
    s_sub_u32 m0, s58, 48128
    ds_read_b64_tr_b16 v[86:87], v14 offset:4608
    v_add_f32 v174, v174, v175
    v_mfma_f32_16x16x32_bf16 v[44:47], v[196:199], a[36:39], v[44:47]
    buffer_load_dword v12, s[4:7], s59 offen lds
    v_cvt_pk_bf16_f32 v171, v172, v174
    v_mfma_f32_16x16x32_bf16 v[44:47], v[200:203], a[40:43], v[44:47]
    s_waitcnt lgkmcnt(10)
    ds_write_b128 v5, v[168:171] offset:34816
    s_waitcnt lgkmcnt(3)
    buffer_store_dwordx4 v[80:83], v2, s[12:15], s55 offen offset:0 sc1
    v_mfma_f32_16x16x32_bf16 v[16:19], v[204:207], a[16:19], v[16:19]
    ds_read_b128 v[160:163], v186 offset:9792
    v_mfma_f32_16x16x32_bf16 v[16:19], v[208:211], a[20:23], v[16:19]
    ds_read_b128 v[164:167], v6 offset:0
    v_mfma_f32_16x16x32_bf16 v[20:23], v[204:207], a[20:23], v[20:23]
    ds_read_b32 v176, v187 offset:8704
    ds_read_b32 v177, v187 offset:1088
    v_mfma_f32_16x16x32_bf16 v[20:23], v[208:211], a[24:27], v[20:23]
    s_waitcnt lgkmcnt(5)
    buffer_store_dwordx4 v[84:87], v2, s[12:15], s48 offen offset:0 sc1
    v_mfma_f32_16x16x32_bf16 v[24:27], v[204:207], a[24:27], v[24:27]
    s_waitcnt lgkmcnt(11)
    s_waitcnt vmcnt(7)
    s_barrier
    v_lshlrev_b32 v104, 16, v80
    v_mfma_f32_16x16x32_bf16 v[24:27], v[208:211], a[28:31], v[24:27]
    v_lshlrev_b32 v105, 16, v84
    v_and_b32 v106, 0xffff0000, v80
    v_and_b32 v107, 0xffff0000, v84
    v_mfma_f32_16x16x32_bf16 v[28:31], v[204:207], a[28:31], v[28:31]
    v_add_f32 v104, v104, v105
    v_add_f32 v106, v106, v107
    v_cvt_pk_bf16_f32 v96, v104, v106
    v_mfma_f32_16x16x32_bf16 v[28:31], v[208:211], a[32:35], v[28:31]
    s_waitcnt lgkmcnt(2)
    v_lshlrev_b32 v172, 16, v160
    v_lshlrev_b32 v173, 16, v164
    v_mfma_f32_16x16x32_bf16 v[32:35], v[204:207], a[32:35], v[32:35]
    v_and_b32 v174, 0xffff0000, v160
    v_and_b32 v175, 0xffff0000, v164
    v_lshlrev_b32 v104, 16, v81
    v_mfma_f32_16x16x32_bf16 v[32:35], v[208:211], a[36:39], v[32:35]
    s_add_u32 m0, s62, 0
    v_add_f32 v172, v172, v173
    v_lshlrev_b32 v105, 16, v85
    v_mfma_f32_16x16x32_bf16 v[36:39], v[204:207], a[36:39], v[36:39]
    buffer_load_dwordx4 v252, s[8:11], 0 offen lds
    v_add_f32 v174, v174, v175
    v_mfma_f32_16x16x32_bf16 v[36:39], v[208:211], a[40:43], v[36:39]
    v_and_b32 v106, 0xffff0000, v81
    v_cvt_pk_bf16_f32 v168, v172, v174
    v_and_b32 v107, 0xffff0000, v85
    v_mfma_f32_16x16x32_bf16 v[40:43], v[204:207], a[40:43], v[40:43]
    v_lshlrev_b32 v172, 16, v161
    v_add_f32 v104, v104, v105
    v_lshlrev_b32 v173, 16, v165
    v_mfma_f32_16x16x32_bf16 v[40:43], v[208:211], a[44:47], v[40:43]
    v_add_f32 v106, v106, v107
    v_and_b32 v174, 0xffff0000, v161
    v_cvt_pk_bf16_f32 v97, v104, v106
    v_mfma_f32_16x16x32_bf16 v[44:47], v[204:207], a[44:47], v[44:47]
    s_add_u32 m0, s62, 4096
    v_and_b32 v175, 0xffff0000, v165
    v_lshlrev_b32 v104, 16, v82
    v_mfma_f32_16x16x32_bf16 v[44:47], v[208:211], a[48:51], v[44:47]
    s_waitcnt lgkmcnt(9)
    buffer_load_dwordx4 v252, s[8:11], s64 offen lds
    v_mfma_f32_16x16x32_bf16 v[16:19], v[212:215], a[24:27], v[16:19]
    v_add_f32 v172, v172, v173
    ds_read_b64_tr_b16 v[220:221], v253 offset:32768
    v_lshlrev_b32 v105, 16, v86
    v_mfma_f32_16x16x32_bf16 v[16:19], v[216:219], a[28:31], v[16:19]
    ds_read_b128 a[60:63], v184 offset:8704
    v_add_f32 v174, v174, v175
    ds_read_b64_tr_b16 v[222:223], v253 offset:33280
    v_mfma_f32_16x16x32_bf16 v[20:23], v[212:215], a[28:31], v[20:23]
    v_and_b32 v106, 0xffff0000, v82
    ds_read_b128 a[64:67], v184 offset:9792
    v_cvt_pk_bf16_f32 v169, v172, v174
    ds_read_b64_tr_b16 v[224:225], v253 offset:36864
    v_and_b32 v107, 0xffff0000, v86
    ds_read_b128 a[68:71], v184 offset:10880
    v_lshlrev_b32 v172, 16, v162
    ds_read_b64_tr_b16 v[226:227], v253 offset:37376
    v_mfma_f32_16x16x32_bf16 v[20:23], v[216:219], a[32:35], v[20:23]
    s_add_u32 m0, s62, 8192
    v_add_f32 v104, v104, v105
    ds_read_b128 a[72:75], v184 offset:11968
    v_lshlrev_b32 v173, 16, v166
    ds_read_b64_tr_b16 v[228:229], v253 offset:40960
    v_add_f32 v106, v106, v107
    ds_read_b128 a[76:79], v184 offset:13056
    v_and_b32 v174, 0xffff0000, v162
    ds_read_b64_tr_b16 v[230:231], v253 offset:41472
    v_mfma_f32_16x16x32_bf16 v[24:27], v[212:215], a[32:35], v[24:27]
    buffer_load_dwordx4 v252, s[8:11], s65 offen lds
    v_cvt_pk_bf16_f32 v98, v104, v106
    ds_read_b128 a[80:83], v184 offset:14144
    v_and_b32 v175, 0xffff0000, v166
    ds_read_b64_tr_b16 v[232:233], v253 offset:45056
    ds_read_b64_tr_b16 v[88:89], v14 offset:8192
    v_lshlrev_b32 v104, 16, v83
    ds_read_b128 a[84:87], v184 offset:15232
    v_add_f32 v172, v172, v173
    ds_read_b64_tr_b16 v[234:235], v253 offset:45568
    v_mfma_f32_16x16x32_bf16 v[24:27], v[216:219], a[36:39], v[24:27]
    ds_read_b64_tr_b16 v[90:91], v14 offset:8704
    v_lshlrev_b32 v105, 16, v87
    ds_read_b128 a[88:91], v184 offset:16320
    v_add_f32 v174, v174, v175
    ds_read_b64_tr_b16 v[236:237], v253 offset:49152
    v_and_b32 v106, 0xffff0000, v83
    ds_read_b128 a[92:95], v185 offset:8704
    v_cvt_pk_bf16_f32 v170, v172, v174
    ds_read_b64_tr_b16 v[238:239], v253 offset:49664
    v_mfma_f32_16x16x32_bf16 v[28:31], v[212:215], a[36:39], v[28:31]
    v_and_b32 v107, 0xffff0000, v87
    ds_read_b128 a[96:99], v185 offset:9792
    v_lshlrev_b32 v172, 16, v163
    s_waitcnt lgkmcnt(15)
    v_lshlrev_b32 v180, 16, v176
    ds_read_b64_tr_b16 v[240:241], v253 offset:53248
    v_add_f32 v104, v104, v105
    ds_read_b128 a[100:103], v185 offset:10880
    v_lshlrev_b32 v173, 16, v167
    v_lshlrev_b32 v181, 16, v177
    ds_read_b64_tr_b16 v[242:243], v253 offset:53760
    v_mfma_f32_16x16x32_bf16 v[28:31], v[216:219], a[40:43], v[28:31]
    v_add_f32 v106, v106, v107
    ds_read_b128 a[104:107], v185 offset:11968
    v_and_b32 v174, 0xffff0000, v163
    v_and_b32 v182, 0xffff0000, v176
    ds_read_b64_tr_b16 v[244:245], v253 offset:57344
    ds_read_b64_tr_b16 v[92:93], v14 offset:12288
    v_cvt_pk_bf16_f32 v99, v104, v106
    ds_read_b128 a[108:111], v185 offset:13056
    v_and_b32 v175, 0xffff0000, v167
    v_and_b32 v183, 0xffff0000, v177
    ds_read_b64_tr_b16 v[246:247], v253 offset:57856
    v_mfma_f32_16x16x32_bf16 v[32:35], v[212:215], a[40:43], v[32:35]
    s_add_u32 m0, s62, 12288
    ds_read_b64_tr_b16 v[94:95], v14 offset:12800
    buffer_store_dwordx4 v[96:99], v2, s[12:15], s49 offen offset:0 sc1
    ds_read_b128 a[112:115], v185 offset:14144
    v_add_f32 v172, v172, v173
    v_add_f32 v180, v180, v181
    ds_read_b64_tr_b16 v[248:249], v254 offset:0
    ds_read_b128 a[116:119], v185 offset:15232
    v_add_f32 v174, v174, v175
    v_add_f32 v182, v182, v183
    ds_read_b64_tr_b16 v[250:251], v254 offset:512
    v_mfma_f32_16x16x32_bf16 v[32:35], v[216:219], a[44:47], v[32:35]
    buffer_load_dwordx4 v252, s[8:11], s66 offen lds
    v_cvt_pk_bf16_f32 v171, v172, v174
    v_cvt_pk_bf16_f32 v178, v180, v182
    ds_write_b128 v5, v[168:171] offset:35904
    ds_write_b32 v7, v178 offset:34816
    v_mfma_f32_16x16x32_bf16 v[36:39], v[212:215], a[44:47], v[36:39]
    s_waitcnt lgkmcnt(15)
    v_lshlrev_b32 v152, 16, v188
    v_lshlrev_b32 v153, 16, v220
    v_mfma_f32_16x16x32_bf16 v[36:39], v[216:219], a[48:51], v[36:39]
    s_waitcnt lgkmcnt(15)
    buffer_store_dwordx4 v[88:91], v2, s[12:15], s55 offen offset:1024 sc1
    v_mfma_f32_16x16x32_bf16 v[40:43], v[212:215], a[48:51], v[40:43]
    v_and_b32 v154, 0xffff0000, v188
    v_and_b32 v155, 0xffff0000, v220
    v_add_f32 v152, v152, v153
    v_mfma_f32_16x16x32_bf16 v[40:43], v[216:219], a[52:55], v[40:43]
    s_add_u32 m0, s62, 16384
    v_add_f32 v154, v154, v155
    v_cvt_pk_bf16_f32 v112, v152, v154
    v_mfma_f32_16x16x32_bf16 v[44:47], v[212:215], a[52:55], v[44:47]
    buffer_load_dwordx4 v252, s[8:11], s67 offen lds
    s_waitcnt lgkmcnt(6)
    buffer_store_dwordx4 v[92:95], v2, s[12:15], s48 offen offset:1024 sc1
    v_lshlrev_b32 v104, 16, v88
    v_mfma_f32_16x16x32_bf16 v[44:47], v[216:219], a[56:59], v[44:47]
    v_lshlrev_b32 v105, 16, v92
    v_and_b32 v106, 0xffff0000, v88
    v_and_b32 v107, 0xffff0000, v92
    s_waitcnt vmcnt(10) lgkmcnt(0)
    s_barrier
    v_mfma_f32_16x16x32_bf16 v[48:51], v[220:223], a[60:63], 0
    v_add_f32 v104, v104, v105
    v_add_f32 v106, v106, v107
    v_cvt_pk_bf16_f32 v100, v104, v106
    v_mfma_f32_16x16x32_bf16 v[48:51], v[224:227], a[64:67], v[48:51]
    v_lshlrev_b32 v152, 16, v189
    v_lshlrev_b32 v104, 16, v89
    v_lshlrev_b32 v153, 16, v221
    v_mfma_f32_16x16x32_bf16 v[52:55], v[220:223], a[64:67], 0
    s_add_u32 m0, s62, 20480
    v_lshlrev_b32 v105, 16, v93
    v_and_b32 v154, 0xffff0000, v189
    v_mfma_f32_16x16x32_bf16 v[52:55], v[224:227], a[68:71], v[52:55]
    buffer_load_dwordx4 v252, s[8:11], s68 offen lds
    v_and_b32 v106, 0xffff0000, v89
    v_and_b32 v155, 0xffff0000, v221
    v_and_b32 v107, 0xffff0000, v93
    v_add_f32 v152, v152, v153
    v_mfma_f32_16x16x32_bf16 v[56:59], v[220:223], a[68:71], 0
    v_add_f32 v104, v104, v105
    v_add_f32 v154, v154, v155
    v_add_f32 v106, v106, v107
    v_cvt_pk_bf16_f32 v113, v152, v154
    v_mfma_f32_16x16x32_bf16 v[56:59], v[224:227], a[72:75], v[56:59]
    v_cvt_pk_bf16_f32 v101, v104, v106
    v_lshlrev_b32 v152, 16, v190
    v_lshlrev_b32 v104, 16, v90
    v_lshlrev_b32 v153, 16, v222
    v_mfma_f32_16x16x32_bf16 v[60:63], v[220:223], a[72:75], 0
    v_lshlrev_b32 v105, 16, v94
    v_and_b32 v154, 0xffff0000, v190
    v_and_b32 v106, 0xffff0000, v90
    v_and_b32 v155, 0xffff0000, v222
    v_mfma_f32_16x16x32_bf16 v[60:63], v[224:227], a[76:79], v[60:63]
    s_add_u32 m0, s62, 24576
    v_and_b32 v107, 0xffff0000, v94
    v_add_f32 v152, v152, v153
    v_add_f32 v104, v104, v105
    v_add_f32 v154, v154, v155
    v_mfma_f32_16x16x32_bf16 v[64:67], v[220:223], a[76:79], 0
    buffer_load_dwordx4 v252, s[8:11], s69 offen lds
    v_add_f32 v106, v106, v107
    v_cvt_pk_bf16_f32 v114, v152, v154
    v_cvt_pk_bf16_f32 v102, v104, v106
    v_lshlrev_b32 v152, 16, v191
    v_mfma_f32_16x16x32_bf16 v[64:67], v[224:227], a[80:83], v[64:67]
    v_lshlrev_b32 v104, 16, v91
    v_lshlrev_b32 v153, 16, v223
    v_lshlrev_b32 v105, 16, v95
    v_and_b32 v154, 0xffff0000, v191
    v_mfma_f32_16x16x32_bf16 v[68:71], v[220:223], a[80:83], 0
    v_and_b32 v106, 0xffff0000, v91
    v_and_b32 v155, 0xffff0000, v223
    v_and_b32 v107, 0xffff0000, v95
    v_add_f32 v152, v152, v153
    v_mfma_f32_16x16x32_bf16 v[68:71], v[224:227], a[84:87], v[68:71]
    v_add_f32 v104, v104, v105
    v_add_f32 v154, v154, v155
    v_add_f32 v106, v106, v107
    v_cvt_pk_bf16_f32 v115, v152, v154
    v_mfma_f32_16x16x32_bf16 v[72:75], v[220:223], a[84:87], 0
    s_add_u32 m0, s62, 28672
    v_cvt_pk_bf16_f32 v103, v104, v106
    v_lshlrev_b32 v152, 16, v192
    buffer_store_dwordx4 v[100:103], v2, s[12:15], s49 offen offset:1024 sc1
    v_lshlrev_b32 v153, 16, v224
    v_mfma_f32_16x16x32_bf16 v[72:75], v[224:227], a[88:91], v[72:75]
    buffer_load_dwordx4 v252, s[8:11], s61 offen lds
    v_and_b32 v154, 0xffff0000, v192
    v_and_b32 v155, 0xffff0000, v224
    v_mfma_f32_16x16x32_bf16 v[76:79], v[220:223], a[88:91], 0
    v_add_f32 v152, v152, v153
    v_add_f32 v154, v154, v155
    v_cvt_pk_bf16_f32 v116, v152, v154
    v_mfma_f32_16x16x32_bf16 v[76:79], v[224:227], a[92:95], v[76:79]
    v_add_u32 v252, 262144, v252
    v_lshlrev_b32 v152, 16, v193
    v_lshlrev_b32 v153, 16, v225
    v_mfma_f32_16x16x32_bf16 v[48:51], v[228:231], a[68:71], v[48:51]
    v_and_b32 v154, 0xffff0000, v193
    v_and_b32 v155, 0xffff0000, v225
    v_add_f32 v152, v152, v153
    v_mfma_f32_16x16x32_bf16 v[48:51], v[232:235], a[72:75], v[48:51]
    s_add_u32 m0, s62, 32768
    v_add_f32 v154, v154, v155
    v_cvt_pk_bf16_f32 v117, v152, v154
    v_mfma_f32_16x16x32_bf16 v[52:55], v[228:231], a[72:75], v[52:55]
    buffer_load_dwordx4 v252, s[8:11], 0 offen lds
    v_lshlrev_b32 v152, 16, v194
    v_mfma_f32_16x16x32_bf16 v[52:55], v[232:235], a[76:79], v[52:55]
    v_lshlrev_b32 v153, 16, v226
    v_and_b32 v154, 0xffff0000, v194
    v_and_b32 v155, 0xffff0000, v226
    v_mfma_f32_16x16x32_bf16 v[56:59], v[228:231], a[76:79], v[56:59]
    v_add_f32 v152, v152, v153
    v_add_f32 v154, v154, v155
    v_cvt_pk_bf16_f32 v118, v152, v154
    v_mfma_f32_16x16x32_bf16 v[56:59], v[232:235], a[80:83], v[56:59]
    v_lshlrev_b32 v152, 16, v195
    v_lshlrev_b32 v153, 16, v227
    v_and_b32 v154, 0xffff0000, v195
    v_mfma_f32_16x16x32_bf16 v[60:63], v[228:231], a[80:83], v[60:63]
    v_and_b32 v155, 0xffff0000, v227
    v_add_f32 v152, v152, v153
    v_add_f32 v154, v154, v155
    v_mfma_f32_16x16x32_bf16 v[60:63], v[232:235], a[84:87], v[60:63]
    s_add_u32 m0, s62, 36864
    v_cvt_pk_bf16_f32 v119, v152, v154
    v_lshlrev_b32 v152, 16, v196
    v_mfma_f32_16x16x32_bf16 v[64:67], v[228:231], a[84:87], v[64:67]
    buffer_load_dwordx4 v252, s[8:11], s64 offen lds
    v_lshlrev_b32 v153, 16, v228
    v_mfma_f32_16x16x32_bf16 v[64:67], v[232:235], a[88:91], v[64:67]
    v_and_b32 v154, 0xffff0000, v196
    v_and_b32 v155, 0xffff0000, v228
    v_add_f32 v152, v152, v153
    v_mfma_f32_16x16x32_bf16 v[68:71], v[228:231], a[88:91], v[68:71]
    v_add_f32 v154, v154, v155
    v_cvt_pk_bf16_f32 v120, v152, v154
    v_lshlrev_b32 v152, 16, v197
    v_mfma_f32_16x16x32_bf16 v[68:71], v[232:235], a[92:95], v[68:71]
    v_lshlrev_b32 v153, 16, v229
    v_and_b32 v154, 0xffff0000, v197
    v_and_b32 v155, 0xffff0000, v229
    v_mfma_f32_16x16x32_bf16 v[72:75], v[228:231], a[92:95], v[72:75]
    v_add_f32 v152, v152, v153
    v_add_f32 v154, v154, v155
    v_cvt_pk_bf16_f32 v121, v152, v154
    v_mfma_f32_16x16x32_bf16 v[72:75], v[232:235], a[96:99], v[72:75]
    s_add_u32 m0, s62, 40960
    v_lshlrev_b32 v152, 16, v198
    v_lshlrev_b32 v153, 16, v230
    v_mfma_f32_16x16x32_bf16 v[76:79], v[228:231], a[96:99], v[76:79]
    buffer_load_dwordx4 v252, s[8:11], s65 offen lds
    v_and_b32 v154, 0xffff0000, v198
    v_mfma_f32_16x16x32_bf16 v[76:79], v[232:235], a[100:103], v[76:79]
    v_and_b32 v155, 0xffff0000, v230
    v_add_f32 v152, v152, v153
    v_add_f32 v154, v154, v155
    v_mfma_f32_16x16x32_bf16 v[48:51], v[236:239], a[76:79], v[48:51]
    v_cvt_pk_bf16_f32 v122, v152, v154
    v_lshlrev_b32 v152, 16, v199
    v_lshlrev_b32 v153, 16, v231
    v_mfma_f32_16x16x32_bf16 v[48:51], v[240:243], a[80:83], v[48:51]
    v_and_b32 v154, 0xffff0000, v199
    v_and_b32 v155, 0xffff0000, v231
    v_add_f32 v152, v152, v153
    v_mfma_f32_16x16x32_bf16 v[52:55], v[236:239], a[80:83], v[52:55]
    v_add_f32 v154, v154, v155
    v_cvt_pk_bf16_f32 v123, v152, v154
    v_lshlrev_b32 v152, 16, v200
    v_mfma_f32_16x16x32_bf16 v[52:55], v[240:243], a[84:87], v[52:55]
    s_add_u32 m0, s62, 45056
    v_lshlrev_b32 v153, 16, v232
    v_and_b32 v154, 0xffff0000, v200
    v_mfma_f32_16x16x32_bf16 v[56:59], v[236:239], a[84:87], v[56:59]
    buffer_load_dwordx4 v252, s[8:11], s66 offen lds
    v_mfma_f32_16x16x32_bf16 v[56:59], v[240:243], a[88:91], v[56:59]
    v_and_b32 v155, 0xffff0000, v232
    v_add_f32 v152, v152, v153
    v_mfma_f32_16x16x32_bf16 v[60:63], v[236:239], a[88:91], v[60:63]
    v_add_f32 v154, v154, v155
    v_cvt_pk_bf16_f32 v124, v152, v154
    v_mfma_f32_16x16x32_bf16 v[60:63], v[240:243], a[92:95], v[60:63]
    v_lshlrev_b32 v152, 16, v201
    v_lshlrev_b32 v153, 16, v233
    v_mfma_f32_16x16x32_bf16 v[64:67], v[236:239], a[92:95], v[64:67]
    v_and_b32 v154, 0xffff0000, v201
    v_and_b32 v155, 0xffff0000, v233
    v_mfma_f32_16x16x32_bf16 v[64:67], v[240:243], a[96:99], v[64:67]
    s_add_u32 m0, s62, 49152
    v_add_f32 v152, v152, v153
    v_mfma_f32_16x16x32_bf16 v[68:71], v[236:239], a[96:99], v[68:71]
    buffer_load_dwordx4 v252, s[8:11], s67 offen lds
    v_mfma_f32_16x16x32_bf16 v[68:71], v[240:243], a[100:103], v[68:71]
    v_add_f32 v154, v154, v155
    v_cvt_pk_bf16_f32 v125, v152, v154
    v_mfma_f32_16x16x32_bf16 v[72:75], v[236:239], a[100:103], v[72:75]
    v_lshlrev_b32 v152, 16, v202
    v_lshlrev_b32 v153, 16, v234
    v_mfma_f32_16x16x32_bf16 v[72:75], v[240:243], a[104:107], v[72:75]
    v_and_b32 v154, 0xffff0000, v202
    v_and_b32 v155, 0xffff0000, v234
    v_mfma_f32_16x16x32_bf16 v[76:79], v[236:239], a[104:107], v[76:79]
    v_add_f32 v152, v152, v153
    ds_read_b128 a[120:123], v3 offset:34816
    v_mfma_f32_16x16x32_bf16 v[76:79], v[240:243], a[108:111], v[76:79]
    s_add_u32 m0, s62, 53248
    v_add_f32 v154, v154, v155
    v_mfma_f32_16x16x32_bf16 v[48:51], v[244:247], a[84:87], v[48:51]
    buffer_load_dwordx4 v252, s[8:11], s68 offen lds
    v_mfma_f32_16x16x32_bf16 v[48:51], v[248:251], a[88:91], v[48:51]
    ds_read_b128 a[124:127], v3 offset:35904
    v_cvt_pk_bf16_f32 v126, v152, v154
    v_mfma_f32_16x16x32_bf16 v[52:55], v[244:247], a[88:91], v[52:55]
    ds_read_b128 a[128:131], v3 offset:36992
    v_lshlrev_b32 v152, 16, v203
    v_mfma_f32_16x16x32_bf16 v[52:55], v[248:251], a[92:95], v[52:55]
    ds_read_b128 a[132:135], v3 offset:38080
    v_lshlrev_b32 v153, 16, v235
    ds_read_b128 a[136:139], v3 offset:39168
    v_and_b32 v154, 0xffff0000, v203
    v_mfma_f32_16x16x32_bf16 v[56:59], v[244:247], a[92:95], v[56:59]
    ds_read_b128 a[140:143], v3 offset:40256
    v_and_b32 v155, 0xffff0000, v235
    ds_read_b128 a[144:147], v3 offset:41344
    v_add_f32 v152, v152, v153
    v_mfma_f32_16x16x32_bf16 v[56:59], v[248:251], a[96:99], v[56:59]
    s_add_u32 m0, s62, 57344
    ds_read_b128 a[148:151], v3 offset:42432
    v_add_f32 v154, v154, v155
    ds_read_b128 a[152:155], v4 offset:34816
    v_cvt_pk_bf16_f32 v127, v152, v154
    v_mfma_f32_16x16x32_bf16 v[60:63], v[244:247], a[96:99], v[60:63]
    buffer_load_dwordx4 v252, s[8:11], s69 offen lds
    ds_read_b128 a[156:159], v4 offset:35904
    v_lshlrev_b32 v152, 16, v204
    ds_read_b128 a[160:163], v4 offset:36992
    v_lshlrev_b32 v153, 16, v236
    v_mfma_f32_16x16x32_bf16 v[60:63], v[248:251], a[100:103], v[60:63]
    ds_read_b128 a[164:167], v4 offset:38080
    v_and_b32 v154, 0xffff0000, v204
    ds_read_b128 a[168:171], v4 offset:39168
    v_and_b32 v155, 0xffff0000, v236
    v_mfma_f32_16x16x32_bf16 v[64:67], v[244:247], a[100:103], v[64:67]
    s_waitcnt vmcnt(8)
    s_mov_b64 exec, s[56:57]
    buffer_store_dwordx2 v[150:151], v148, s[32:35], 0 offen offset:0 sc1
    s_mov_b64 exec, -1
    ds_read_b128 a[172:175], v4 offset:40256
    v_add_f32 v152, v152, v153
    ds_read_b128 a[176:179], v4 offset:41344
    v_add_f32 v154, v154, v155
    v_mfma_f32_16x16x32_bf16 v[64:67], v[248:251], a[104:107], v[64:67]
    v_cvt_pk_bf16_f32 v128, v152, v154
    v_lshlrev_b32 v152, 16, v205
    v_mfma_f32_16x16x32_bf16 v[68:71], v[244:247], a[104:107], v[68:71]
    v_lshlrev_b32 v153, 16, v237
    v_and_b32 v154, 0xffff0000, v205
    v_mfma_f32_16x16x32_bf16 v[68:71], v[248:251], a[108:111], v[68:71]
    v_and_b32 v155, 0xffff0000, v237
    v_add_f32 v152, v152, v153
    v_mfma_f32_16x16x32_bf16 v[72:75], v[244:247], a[108:111], v[72:75]
    v_add_f32 v154, v154, v155
    v_cvt_pk_bf16_f32 v129, v152, v154
    v_mfma_f32_16x16x32_bf16 v[72:75], v[248:251], a[112:115], v[72:75]
    v_lshlrev_b32 v152, 16, v206
    v_lshlrev_b32 v153, 16, v238
    v_mfma_f32_16x16x32_bf16 v[76:79], v[244:247], a[112:115], v[76:79]
    v_and_b32 v154, 0xffff0000, v206
    v_and_b32 v155, 0xffff0000, v238
    v_mfma_f32_16x16x32_bf16 v[76:79], v[248:251], a[116:119], v[76:79]
    s_waitcnt vmcnt(8)
    s_barrier
    v_add_f32 v152, v152, v153
    v_add_f32 v154, v154, v155
    s_waitcnt lgkmcnt(0)
    v_mfma_f32_16x16x32_bf16 v[80:83], v[112:115], a[120:123], 0
    v_cvt_pk_bf16_f32 v130, v152, v154
    v_lshlrev_b32 v152, 16, v207
    v_mfma_f32_16x16x32_bf16 v[80:83], v[116:119], a[124:127], v[80:83]
    v_lshlrev_b32 v153, 16, v239
    v_and_b32 v154, 0xffff0000, v207
    v_mfma_f32_16x16x32_bf16 v[84:87], v[112:115], a[124:127], 0
    v_and_b32 v155, 0xffff0000, v239
    v_add_f32 v152, v152, v153
    v_mfma_f32_16x16x32_bf16 v[84:87], v[116:119], a[128:131], v[84:87]
    v_add_f32 v154, v154, v155
    v_cvt_pk_bf16_f32 v131, v152, v154
    v_mfma_f32_16x16x32_bf16 v[88:91], v[112:115], a[128:131], 0
    v_lshlrev_b32 v152, 16, v208
    v_lshlrev_b32 v153, 16, v240
    v_mfma_f32_16x16x32_bf16 v[88:91], v[116:119], a[132:135], v[88:91]
    s_add_u32 m0, s47, 0
    v_and_b32 v154, 0xffff0000, v208
    v_and_b32 v155, 0xffff0000, v240
    v_mfma_f32_16x16x32_bf16 v[92:95], v[112:115], a[132:135], 0
    buffer_load_dwordx4 v8, s[4:7], s45 offen lds
    v_add_f32 v152, v152, v153
    v_add_f32 v154, v154, v155
    v_mfma_f32_16x16x32_bf16 v[92:95], v[116:119], a[136:139], v[92:95]
    v_cvt_pk_bf16_f32 v132, v152, v154
    v_lshlrev_b32 v152, 16, v209
    v_mfma_f32_16x16x32_bf16 v[96:99], v[112:115], a[136:139], 0
    v_lshlrev_b32 v153, 16, v241
    v_and_b32 v154, 0xffff0000, v209
    v_mfma_f32_16x16x32_bf16 v[96:99], v[116:119], a[140:143], v[96:99]
    v_and_b32 v155, 0xffff0000, v241
    v_add_f32 v152, v152, v153
    v_mfma_f32_16x16x32_bf16 v[100:103], v[112:115], a[140:143], 0
    v_add_f32 v154, v154, v155
    v_cvt_pk_bf16_f32 v133, v152, v154
    v_mfma_f32_16x16x32_bf16 v[100:103], v[116:119], a[144:147], v[100:103]
    v_lshlrev_b32 v152, 16, v210
    v_lshlrev_b32 v153, 16, v242
    v_mfma_f32_16x16x32_bf16 v[104:107], v[112:115], a[144:147], 0
L_pg0:
    s_cbranch_execz L_tret
    s_add_u32 m0, s47, 4096
    v_and_b32 v154, 0xffff0000, v210
    v_and_b32 v155, 0xffff0000, v242
    v_mfma_f32_16x16x32_bf16 v[104:107], v[116:119], a[148:151], v[104:107]
    buffer_load_dwordx4 v9, s[4:7], s45 offen lds
    v_add_f32 v152, v152, v153
    v_add_f32 v154, v154, v155
    v_mfma_f32_16x16x32_bf16 v[108:111], v[112:115], a[148:151], 0
    v_cvt_pk_bf16_f32 v134, v152, v154
    v_lshlrev_b32 v152, 16, v211
    v_mfma_f32_16x16x32_bf16 v[108:111], v[116:119], a[152:155], v[108:111]
    v_lshlrev_b32 v153, 16, v243
    v_and_b32 v154, 0xffff0000, v211
    v_mfma_f32_16x16x32_bf16 v[80:83], v[120:123], a[128:131], v[80:83]
    v_and_b32 v155, 0xffff0000, v243
    v_add_f32 v152, v152, v153
    v_mfma_f32_16x16x32_bf16 v[80:83], v[124:127], a[132:135], v[80:83]
    v_add_f32 v154, v154, v155
    v_cvt_pk_bf16_f32 v135, v152, v154
    v_mfma_f32_16x16x32_bf16 v[84:87], v[120:123], a[132:135], v[84:87]
    v_lshlrev_b32 v152, 16, v212
    v_lshlrev_b32 v153, 16, v244
    v_mfma_f32_16x16x32_bf16 v[84:87], v[124:127], a[136:139], v[84:87]
    s_add_u32 m0, s47, 8192
    v_and_b32 v154, 0xffff0000, v212
    v_and_b32 v155, 0xffff0000, v244
    v_mfma_f32_16x16x32_bf16 v[88:91], v[120:123], a[136:139], v[88:91]
    buffer_load_dwordx4 v10, s[4:7], s45 offen lds
    v_add_f32 v152, v152, v153
    v_add_f32 v154, v154, v155
    v_mfma_f32_16x16x32_bf16 v[88:91], v[124:127], a[140:143], v[88:91]
    v_cvt_pk_bf16_f32 v136, v152, v154
    v_lshlrev_b32 v152, 16, v213
    v_mfma_f32_16x16x32_bf16 v[92:95], v[120:123], a[140:143], v[92:95]
    v_lshlrev_b32 v153, 16, v245
    v_and_b32 v154, 0xffff0000, v213
    v_mfma_f32_16x16x32_bf16 v[92:95], v[124:127], a[144:147], v[92:95]
    v_and_b32 v155, 0xffff0000, v245
    v_add_f32 v152, v152, v153
    v_mfma_f32_16x16x32_bf16 v[96:99], v[120:123], a[144:147], v[96:99]
    v_add_f32 v154, v154, v155
    v_cvt_pk_bf16_f32 v137, v152, v154
    v_mfma_f32_16x16x32_bf16 v[96:99], v[124:127], a[148:151], v[96:99]
    v_lshlrev_b32 v152, 16, v214
    v_lshlrev_b32 v153, 16, v246
    v_mfma_f32_16x16x32_bf16 v[100:103], v[120:123], a[148:151], v[100:103]
    s_add_u32 m0, s47, 12288
    v_and_b32 v154, 0xffff0000, v214
    v_and_b32 v155, 0xffff0000, v246
    v_mfma_f32_16x16x32_bf16 v[100:103], v[124:127], a[152:155], v[100:103]
    buffer_load_dwordx4 v11, s[4:7], s45 offen lds
    v_add_f32 v152, v152, v153
    v_add_f32 v154, v154, v155
    v_mfma_f32_16x16x32_bf16 v[104:107], v[120:123], a[152:155], v[104:107]
    v_cvt_pk_bf16_f32 v138, v152, v154
    v_lshlrev_b32 v152, 16, v215
    v_mfma_f32_16x16x32_bf16 v[104:107], v[124:127], a[156:159], v[104:107]
    v_lshlrev_b32 v153, 16, v247
    v_and_b32 v154, 0xffff0000, v215
    v_mfma_f32_16x16x32_bf16 v[108:111], v[120:123], a[156:159], v[108:111]
    v_and_b32 v155, 0xffff0000, v247
    v_add_f32 v152, v152, v153
    v_mfma_f32_16x16x32_bf16 v[108:111], v[124:127], a[160:163], v[108:111]
    v_add_f32 v154, v154, v155
    v_cvt_pk_bf16_f32 v139, v152, v154
    v_mfma_f32_16x16x32_bf16 v[80:83], v[128:131], a[136:139], v[80:83]
    v_lshlrev_b32 v152, 16, v216
    v_lshlrev_b32 v153, 16, v248
    v_mfma_f32_16x16x32_bf16 v[80:83], v[132:135], a[140:143], v[80:83]
    s_add_u32 m0, s58, 0
    v_and_b32 v154, 0xffff0000, v216
    v_and_b32 v155, 0xffff0000, v248
    v_mfma_f32_16x16x32_bf16 v[84:87], v[128:131], a[140:143], v[84:87]
    buffer_load_dword v12, s[4:7], s45 offen lds
    v_add_f32 v152, v152, v153
    v_add_f32 v154, v154, v155
    v_mfma_f32_16x16x32_bf16 v[84:87], v[132:135], a[144:147], v[84:87]
    v_cvt_pk_bf16_f32 v140, v152, v154
    v_lshlrev_b32 v152, 16, v217
    v_mfma_f32_16x16x32_bf16 v[88:91], v[128:131], a[144:147], v[88:91]
    v_lshlrev_b32 v153, 16, v249
    v_and_b32 v154, 0xffff0000, v217
    v_mfma_f32_16x16x32_bf16 v[88:91], v[132:135], a[148:151], v[88:91]
    v_and_b32 v155, 0xffff0000, v249
    v_add_f32 v152, v152, v153
    v_mfma_f32_16x16x32_bf16 v[92:95], v[128:131], a[148:151], v[92:95]
    v_add_f32 v154, v154, v155
    v_cvt_pk_bf16_f32 v141, v152, v154
    v_mfma_f32_16x16x32_bf16 v[92:95], v[132:135], a[152:155], v[92:95]
    v_lshlrev_b32 v152, 16, v218
    v_lshlrev_b32 v153, 16, v250
    v_mfma_f32_16x16x32_bf16 v[96:99], v[128:131], a[152:155], v[96:99]
    v_and_b32 v154, 0xffff0000, v218
    v_and_b32 v155, 0xffff0000, v250
    v_mfma_f32_16x16x32_bf16 v[96:99], v[132:135], a[156:159], v[96:99]
    v_add_f32 v152, v152, v153
    v_add_f32 v154, v154, v155
    v_mfma_f32_16x16x32_bf16 v[100:103], v[128:131], a[156:159], v[100:103]
    s_waitcnt vmcnt(6)
    s_barrier
    v_cvt_pk_bf16_f32 v142, v152, v154
    v_lshlrev_b32 v152, 16, v219
    v_mfma_f32_16x16x32_bf16 v[100:103], v[132:135], a[160:163], v[100:103]
    v_lshlrev_b32 v153, 16, v251
    v_and_b32 v154, 0xffff0000, v219
    v_mfma_f32_16x16x32_bf16 v[104:107], v[128:131], a[160:163], v[104:107]
    v_and_b32 v155, 0xffff0000, v251
    v_add_f32 v152, v152, v153
    v_mfma_f32_16x16x32_bf16 v[104:107], v[132:135], a[164:167], v[104:107]
    v_add_f32 v154, v154, v155
    v_cvt_pk_bf16_f32 v143, v152, v154
    v_mfma_f32_16x16x32_bf16 v[108:111], v[128:131], a[164:167], v[108:111]
    ds_read_b64_tr_b16 v[188:189], v253 offset:0
    ds_read_b128 a[0:3], v184 offset:17408
    v_mfma_f32_16x16x32_bf16 v[108:111], v[132:135], a[168:171], v[108:111]
    ds_read_b64_tr_b16 v[190:191], v253 offset:512
    ds_read_b128 a[4:7], v184 offset:18496
    v_mfma_f32_16x16x32_bf16 v[80:83], v[136:139], a[144:147], v[80:83]
    ds_read_b64_tr_b16 v[192:193], v253 offset:4096
    ds_read_b64_tr_b16 v[194:195], v253 offset:4608
    v_mfma_f32_16x16x32_bf16 v[80:83], v[140:143], a[148:151], v[80:83]
    ds_read_b128 a[8:11], v184 offset:19584
    v_mfma_f32_16x16x32_bf16 v[84:87], v[136:139], a[148:151], v[84:87]
    global_load_ushort v144, v13, s[22:23]
    v_mfma_f32_16x16x32_bf16 v[84:87], v[140:143], a[152:155], v[84:87]
    ds_read_b128 a[12:15], v184 offset:20672
    ds_read_b64_tr_b16 v[196:197], v253 offset:8192
    ds_read_b128 a[16:19], v184 offset:21760
    ds_read_b64_tr_b16 v[198:199], v253 offset:8704
    v_mfma_f32_16x16x32_bf16 v[88:91], v[136:139], a[152:155], v[88:91]
    ds_read_b128 a[20:23], v184 offset:22848
    ds_read_b64_tr_b16 v[200:201], v253 offset:12288
    ds_read_b128 a[24:27], v184 offset:23936
    ds_read_b64_tr_b16 v[202:203], v253 offset:12800
    v_mfma_f32_16x16x32_bf16 v[88:91], v[140:143], a[156:159], v[88:91]
    ds_read_b128 a[28:31], v184 offset:25024
    ds_read_b64_tr_b16 v[204:205], v253 offset:16384
    ds_read_b128 a[32:35], v185 offset:17408
    ds_read_b64_tr_b16 v[206:207], v253 offset:16896
    v_mfma_f32_16x16x32_bf16 v[92:95], v[136:139], a[156:159], v[92:95]
    ds_read_b128 a[36:39], v185 offset:18496
    ds_read_b64_tr_b16 v[208:209], v253 offset:20480
    ds_read_b128 a[40:43], v185 offset:19584
    ds_read_b64_tr_b16 v[210:211], v253 offset:20992
    v_mfma_f32_16x16x32_bf16 v[92:95], v[140:143], a[160:163], v[92:95]
    ds_read_b128 a[44:47], v185 offset:20672
    ds_read_b64_tr_b16 v[212:213], v253 offset:24576
    ds_read_b128 a[48:51], v185 offset:21760
    ds_read_b64_tr_b16 v[214:215], v253 offset:25088
    v_mfma_f32_16x16x32_bf16 v[96:99], v[136:139], a[160:163], v[96:99]
    global_load_ushort v145, v13, s[24:25]
    ds_read_b128 a[52:55], v185 offset:22848
    ds_read_b64_tr_b16 v[216:217], v253 offset:28672
    ds_read_b128 a[56:59], v185 offset:23936
    ds_read_b64_tr_b16 v[218:219], v253 offset:29184
    v_mfma_f32_16x16x32_bf16 v[96:99], v[140:143], a[164:167], v[96:99]
    v_mfma_f32_16x16x32_bf16 v[100:103], v[136:139], a[164:167], v[100:103]
    v_mfma_f32_16x16x32_bf16 v[100:103], v[140:143], a[168:171], v[100:103]
    v_mfma_f32_16x16x32_bf16 v[104:107], v[136:139], a[168:171], v[104:107]
    v_mfma_f32_16x16x32_bf16 v[104:107], v[140:143], a[172:175], v[104:107]
    v_mfma_f32_16x16x32_bf16 v[108:111], v[136:139], a[172:175], v[108:111]
    global_load_ushort v146, v13, s[20:21]
    v_mfma_f32_16x16x32_bf16 v[108:111], v[140:143], a[176:179], v[108:111]
    s_waitcnt lgkmcnt(0)
    v_mfma_f32_16x16x32_bf16 v[16:19], v[188:191], a[0:3], v[16:19]
    v_mfma_f32_16x16x32_bf16 v[16:19], v[192:195], a[4:7], v[16:19]
    v_mfma_f32_16x16x32_bf16 v[20:23], v[188:191], a[4:7], v[20:23]
    v_mfma_f32_16x16x32_bf16 v[20:23], v[192:195], a[8:11], v[20:23]
    v_mfma_f32_16x16x32_bf16 v[24:27], v[188:191], a[8:11], v[24:27]
    ds_read_b128 v[160:163], v186 offset:26112
    v_mfma_f32_16x16x32_bf16 v[24:27], v[192:195], a[12:15], v[24:27]
    ds_read_b128 v[164:167], v186 offset:18496
    v_mfma_f32_16x16x32_bf16 v[28:31], v[188:191], a[12:15], v[28:31]
    ds_read_b32 v176, v187 offset:26112
    ds_read_b32 v177, v187 offset:18496
    v_mfma_f32_16x16x32_bf16 v[28:31], v[192:195], a[16:19], v[28:31]
    s_add_u32 m0, s47, 17408
    ds_read_b128 a[60:63], v184 offset:26112
    v_mfma_f32_16x16x32_bf16 v[32:35], v[188:191], a[16:19], v[32:35]
    buffer_load_dwordx4 v8, s[4:7], s60 offen lds
    v_mfma_f32_16x16x32_bf16 v[32:35], v[192:195], a[20:23], v[32:35]
    ds_read_b128 a[64:67], v184 offset:27200
    v_mfma_f32_16x16x32_bf16 v[36:39], v[188:191], a[20:23], v[36:39]
    ds_read_b64_tr_b16 v[220:221], v253 offset:32768
    ds_read_b64_tr_b16 v[222:223], v253 offset:33280
    v_mfma_f32_16x16x32_bf16 v[36:39], v[192:195], a[24:27], v[36:39]
    s_waitcnt lgkmcnt(6)
    v_lshlrev_b32 v172, 16, v160
    v_mfma_f32_16x16x32_bf16 v[40:43], v[188:191], a[24:27], v[40:43]
    v_lshlrev_b32 v173, 16, v164
    v_and_b32 v174, 0xffff0000, v160
    v_mfma_f32_16x16x32_bf16 v[40:43], v[192:195], a[28:31], v[40:43]
    v_and_b32 v175, 0xffff0000, v164
    v_add_f32 v172, v172, v173
    v_mfma_f32_16x16x32_bf16 v[44:47], v[188:191], a[28:31], v[44:47]
    buffer_load_dwordx2 v[150:151], v149, s[32:35], 0 offen offset:0 sc1
    v_mfma_f32_16x16x32_bf16 v[44:47], v[192:195], a[32:35], v[44:47]
    v_add_f32 v174, v174, v175
    v_cvt_pk_bf16_f32 v168, v172, v174
    v_mfma_f32_16x16x32_bf16 v[16:19], v[196:199], a[8:11], v[16:19]
    v_lshlrev_b32 v172, 16, v161
    v_lshlrev_b32 v173, 16, v165
    v_mfma_f32_16x16x32_bf16 v[16:19], v[200:203], a[12:15], v[16:19]
    v_and_b32 v174, 0xffff0000, v161
    v_and_b32 v175, 0xffff0000, v165
    v_mfma_f32_16x16x32_bf16 v[20:23], v[196:199], a[12:15], v[20:23]
    v_add_f32 v172, v172, v173
    v_add_f32 v174, v174, v175
    v_mfma_f32_16x16x32_bf16 v[20:23], v[200:203], a[16:19], v[20:23]
    v_cvt_pk_bf16_f32 v169, v172, v174
    v_lshlrev_b32 v172, 16, v162
    v_mfma_f32_16x16x32_bf16 v[24:27], v[196:199], a[16:19], v[24:27]
    v_lshlrev_b32 v173, 16, v166
    v_and_b32 v174, 0xffff0000, v162
    v_mfma_f32_16x16x32_bf16 v[24:27], v[200:203], a[20:23], v[24:27]
    v_and_b32 v175, 0xffff0000, v166
    v_add_f32 v172, v172, v173
    v_mfma_f32_16x16x32_bf16 v[28:31], v[196:199], a[20:23], v[28:31]
    v_add_f32 v174, v174, v175
    v_cvt_pk_bf16_f32 v170, v172, v174
    v_mfma_f32_16x16x32_bf16 v[28:31], v[200:203], a[24:27], v[28:31]
    v_lshlrev_b32 v172, 16, v163
    v_lshlrev_b32 v173, 16, v167
    v_mfma_f32_16x16x32_bf16 v[32:35], v[196:199], a[24:27], v[32:35]
    v_and_b32 v174, 0xffff0000, v163
    v_and_b32 v175, 0xffff0000, v167
    v_mfma_f32_16x16x32_bf16 v[32:35], v[200:203], a[28:31], v[32:35]
    v_add_f32 v172, v172, v173
    v_add_f32 v174, v174, v175
    v_mfma_f32_16x16x32_bf16 v[36:39], v[196:199], a[28:31], v[36:39]
    v_cvt_pk_bf16_f32 v171, v172, v174
    ds_write_b128 v5, v[168:171] offset:43520
    v_mfma_f32_16x16x32_bf16 v[36:39], v[200:203], a[32:35], v[36:39]
    ds_read_b128 v[160:163], v186 offset:27200
    s_waitcnt lgkmcnt(6)
    v_lshlrev_b32 v180, 16, v176
    v_mfma_f32_16x16x32_bf16 v[40:43], v[196:199], a[32:35], v[40:43]
    ds_read_b128 v[164:167], v6 offset:17408
    v_lshlrev_b32 v181, 16, v177
    v_mfma_f32_16x16x32_bf16 v[40:43], v[200:203], a[36:39], v[40:43]
    v_and_b32 v182, 0xffff0000, v176
    v_and_b32 v183, 0xffff0000, v177
    v_mfma_f32_16x16x32_bf16 v[44:47], v[196:199], a[36:39], v[44:47]
    v_add_f32 v180, v180, v181
    v_add_f32 v182, v182, v183
    v_mfma_f32_16x16x32_bf16 v[44:47], v[200:203], a[40:43], v[44:47]
    v_cvt_pk_bf16_f32 v178, v180, v182
    ds_write_b32 v7, v178 offset:43520
    v_mfma_f32_16x16x32_bf16 v[16:19], v[204:207], a[16:19], v[16:19]
    ds_read_b128 a[68:71], v184 offset:28288
    ds_read_b128 a[72:75], v184 offset:29376
    v_mfma_f32_16x16x32_bf16 v[16:19], v[208:211], a[20:23], v[16:19]
    ds_read_b64_tr_b16 v[224:225], v253 offset:36864
    ds_read_b64_tr_b16 v[226:227], v253 offset:37376
    v_mfma_f32_16x16x32_bf16 v[20:23], v[204:207], a[20:23], v[20:23]
    s_waitcnt lgkmcnt(5)
    v_lshlrev_b32 v172, 16, v160
    v_mfma_f32_16x16x32_bf16 v[20:23], v[208:211], a[24:27], v[20:23]
    v_lshlrev_b32 v173, 16, v164
    v_and_b32 v174, 0xffff0000, v160
    v_mfma_f32_16x16x32_bf16 v[24:27], v[204:207], a[24:27], v[24:27]
    v_and_b32 v175, 0xffff0000, v164
    v_add_f32 v172, v172, v173
    v_mfma_f32_16x16x32_bf16 v[24:27], v[208:211], a[28:31], v[24:27]
    v_add_f32 v174, v174, v175
    v_cvt_pk_bf16_f32 v168, v172, v174
    v_mfma_f32_16x16x32_bf16 v[28:31], v[204:207], a[28:31], v[28:31]
    v_lshlrev_b32 v172, 16, v161
    v_lshlrev_b32 v173, 16, v165
    v_mfma_f32_16x16x32_bf16 v[28:31], v[208:211], a[32:35], v[28:31]
    v_and_b32 v174, 0xffff0000, v161
    v_and_b32 v175, 0xffff0000, v165
    v_mfma_f32_16x16x32_bf16 v[32:35], v[204:207], a[32:35], v[32:35]
    v_add_f32 v172, v172, v173
    v_add_f32 v174, v174, v175
    v_mfma_f32_16x16x32_bf16 v[32:35], v[208:211], a[36:39], v[32:35]
    v_cvt_pk_bf16_f32 v169, v172, v174
    v_lshlrev_b32 v172, 16, v162
    v_mfma_f32_16x16x32_bf16 v[36:39], v[204:207], a[36:39], v[36:39]
    v_lshlrev_b32 v173, 16, v166
    v_and_b32 v174, 0xffff0000, v162
    v_mfma_f32_16x16x32_bf16 v[36:39], v[208:211], a[40:43], v[36:39]
    v_and_b32 v175, 0xffff0000, v166
    v_add_f32 v172, v172, v173
    v_mfma_f32_16x16x32_bf16 v[40:43], v[204:207], a[40:43], v[40:43]
    ds_read_b128 a[76:79], v184 offset:30464
    v_add_f32 v174, v174, v175
    v_mfma_f32_16x16x32_bf16 v[40:43], v[208:211], a[44:47], v[40:43]
    ds_read_b128 a[80:83], v184 offset:31552
    ds_read_b64_tr_b16 v[228:229], v253 offset:40960
    v_mfma_f32_16x16x32_bf16 v[44:47], v[204:207], a[44:47], v[44:47]
    v_cvt_pk_bf16_f32 v170, v172, v174
    ds_read_b128 a[84:87], v184 offset:32640
    v_mfma_f32_16x16x32_bf16 v[44:47], v[208:211], a[48:51], v[44:47]
    ds_read_b64_tr_b16 v[230:231], v253 offset:41472
    v_lshlrev_b32 v172, 16, v163
    v_mfma_f32_16x16x32_bf16 v[16:19], v[212:215], a[24:27], v[16:19]
    ds_read_b128 a[88:91], v184 offset:33728
    ds_read_b64_tr_b16 v[232:233], v253 offset:45056
    v_mfma_f32_16x16x32_bf16 v[16:19], v[216:219], a[28:31], v[16:19]
    v_lshlrev_b32 v173, 16, v167
    ds_read_b128 a[92:95], v185 offset:26112
    v_mfma_f32_16x16x32_bf16 v[20:23], v[212:215], a[28:31], v[20:23]
    ds_read_b64_tr_b16 v[234:235], v253 offset:45568
    v_and_b32 v174, 0xffff0000, v163
    v_mfma_f32_16x16x32_bf16 v[20:23], v[216:219], a[32:35], v[20:23]
    ds_read_b128 a[96:99], v185 offset:27200
    ds_read_b64_tr_b16 v[236:237], v253 offset:49152
    v_mfma_f32_16x16x32_bf16 v[24:27], v[212:215], a[32:35], v[24:27]
    v_and_b32 v175, 0xffff0000, v167
    ds_read_b128 a[100:103], v185 offset:28288
    v_mfma_f32_16x16x32_bf16 v[24:27], v[216:219], a[36:39], v[24:27]
    ds_read_b64_tr_b16 v[238:239], v253 offset:49664
    v_add_f32 v172, v172, v173
    v_mfma_f32_16x16x32_bf16 v[28:31], v[212:215], a[36:39], v[28:31]
    ds_read_b128 a[104:107], v185 offset:29376
    ds_read_b64_tr_b16 v[240:241], v253 offset:53248
    v_mfma_f32_16x16x32_bf16 v[28:31], v[216:219], a[40:43], v[28:31]
    v_add_f32 v174, v174, v175
    ds_read_b128 a[108:111], v185 offset:30464
    ds_read_b64_tr_b16 v[242:243], v253 offset:53760
    v_mfma_f32_16x16x32_bf16 v[32:35], v[212:215], a[40:43], v[32:35]
    v_cvt_pk_bf16_f32 v171, v172, v174
    ds_read_b128 a[112:115], v185 offset:31552
    ds_read_b64_tr_b16 v[244:245], v253 offset:57344
    ds_write_b128 v5, v[168:171] offset:44608
    ds_read_b128 a[116:119], v185 offset:32640
    ds_read_b64_tr_b16 v[246:247], v253 offset:57856
    v_mfma_f32_16x16x32_bf16 v[32:35], v[216:219], a[44:47], v[32:35]
    v_mfma_f32_16x16x32_bf16 v[36:39], v[212:215], a[44:47], v[36:39]
    s_waitcnt vmcnt(0)
    v_cmp_eq_u32 vcc, s41, v150
    v_xor_b32 v184, 65536, v184
    v_mfma_f32_16x16x32_bf16 v[36:39], v[216:219], a[48:51], v[36:39]
    v_cmp_eq_u32 s[50:51], s42, v151
    v_xor_b32 v185, 65536, v185
    v_mfma_f32_16x16x32_bf16 v[40:43], v[212:215], a[48:51], v[40:43]
    v_xor_b32 v186, 65536, v186
    v_mfma_f32_16x16x32_bf16 v[40:43], v[216:219], a[52:55], v[40:43]
    s_and_b64 vcc, vcc, s[50:51]
    s_andn2_b64 vcc, 0xff, vcc
    s_cbranch_scc1 L_spinA
L_spinA_ret:
    v_xor_b32 v6, 65536, v6
    v_mfma_f32_16x16x32_bf16 v[44:47], v[212:215], a[52:55], v[44:47]
    v_xor_b32 v187, 65536, v187
    v_mfma_f32_16x16x32_bf16 v[44:47], v[216:219], a[56:59], v[44:47]
    s_waitcnt vmcnt(5) lgkmcnt(0)
    s_barrier
    v_mfma_f32_16x16x32_bf16 v[48:51], v[220:223], a[60:63], v[48:51]
    buffer_load_dwordx4 v[112:115], v2, s[12:15], s98 offen offset:0 sc1
    v_mfma_f32_16x16x32_bf16 v[48:51], v[224:227], a[64:67], v[48:51]
    ds_read_b128 a[120:123], v3 offset:43520
    ds_read_b128 a[124:127], v3 offset:44608
    v_mfma_f32_16x16x32_bf16 v[52:55], v[220:223], a[64:67], v[52:55]
    ds_read_b128 a[128:131], v3 offset:45696
    v_mfma_f32_16x16x32_bf16 v[52:55], v[224:227], a[68:71], v[52:55]
    ds_read_b128 a[132:135], v3 offset:46784
    v_mfma_f32_16x16x32_bf16 v[56:59], v[220:223], a[68:71], v[56:59]
    buffer_load_dwordx4 v[116:119], v2, s[12:15], s98 offen offset:1024 sc1
    v_mfma_f32_16x16x32_bf16 v[56:59], v[224:227], a[72:75], v[56:59]
    ds_read_b128 a[136:139], v3 offset:47872
    ds_read_b128 a[140:143], v3 offset:48960
    v_mfma_f32_16x16x32_bf16 v[60:63], v[220:223], a[72:75], v[60:63]
    ds_read_b128 a[144:147], v3 offset:50048
    v_mfma_f32_16x16x32_bf16 v[60:63], v[224:227], a[76:79], v[60:63]
    ds_read_b128 a[148:151], v3 offset:51136
    v_mfma_f32_16x16x32_bf16 v[64:67], v[220:223], a[76:79], v[64:67]
    buffer_load_dwordx4 v[120:123], v2, s[12:15], s98 offen offset:2048 sc1
    v_mfma_f32_16x16x32_bf16 v[64:67], v[224:227], a[80:83], v[64:67]
    ds_read_b128 a[152:155], v4 offset:43520
    ds_read_b128 a[156:159], v4 offset:44608
    v_mfma_f32_16x16x32_bf16 v[68:71], v[220:223], a[80:83], v[68:71]
    ds_read_b128 a[160:163], v4 offset:45696
    v_mfma_f32_16x16x32_bf16 v[68:71], v[224:227], a[84:87], v[68:71]
    ds_read_b128 a[164:167], v4 offset:46784
    v_mfma_f32_16x16x32_bf16 v[72:75], v[220:223], a[84:87], v[72:75]
    buffer_load_dwordx4 v[124:127], v2, s[12:15], s98 offen offset:3072 sc1
    v_mfma_f32_16x16x32_bf16 v[72:75], v[224:227], a[88:91], v[72:75]
    ds_read_b128 a[168:171], v4 offset:47872
    ds_read_b128 a[172:175], v4 offset:48960
    v_mfma_f32_16x16x32_bf16 v[76:79], v[220:223], a[88:91], v[76:79]
    ds_read_b128 a[176:179], v4 offset:50048
    v_mfma_f32_16x16x32_bf16 v[76:79], v[224:227], a[92:95], v[76:79]
    ds_read_b128 v[160:163], v186 offset:8704
    v_mfma_f32_16x16x32_bf16 v[48:51], v[228:231], a[68:71], v[48:51]
    buffer_load_dwordx4 v[128:131], v2, s[12:15], s99 offen offset:0 sc1
    v_mfma_f32_16x16x32_bf16 v[48:51], v[232:235], a[72:75], v[48:51]
    ds_read_b128 v[164:167], v186 offset:1088
    ds_read_b32 v176, v187 offset:8704
    v_mfma_f32_16x16x32_bf16 v[52:55], v[228:231], a[72:75], v[52:55]
    ds_read_b32 v177, v187 offset:1088
    ds_read_b128 a[0:3], v184 offset:0
    v_mfma_f32_16x16x32_bf16 v[52:55], v[232:235], a[76:79], v[52:55]
    ds_read_b128 a[4:7], v184 offset:1088
    v_mfma_f32_16x16x32_bf16 v[56:59], v[228:231], a[76:79], v[56:59]
    buffer_load_dwordx4 v[132:135], v2, s[12:15], s99 offen offset:1024 sc1
    v_mfma_f32_16x16x32_bf16 v[56:59], v[232:235], a[80:83], v[56:59]
    ds_read_b128 a[8:11], v184 offset:2176
    ds_read_b128 a[12:15], v184 offset:3264
    v_mfma_f32_16x16x32_bf16 v[60:63], v[228:231], a[80:83], v[60:63]
    ds_read_b128 a[16:19], v184 offset:4352
    v_mfma_f32_16x16x32_bf16 v[60:63], v[232:235], a[84:87], v[60:63]
    s_waitcnt lgkmcnt(7)
    v_lshlrev_b32 v172, 16, v160
    v_mfma_f32_16x16x32_bf16 v[64:67], v[228:231], a[84:87], v[64:67]
    buffer_load_dwordx4 v[136:139], v2, s[12:15], s99 offen offset:2048 sc1
    v_mfma_f32_16x16x32_bf16 v[64:67], v[232:235], a[88:91], v[64:67]
    v_lshlrev_b32 v173, 16, v164
    v_and_b32 v174, 0xffff0000, v160
    v_mfma_f32_16x16x32_bf16 v[68:71], v[228:231], a[88:91], v[68:71]
    v_and_b32 v175, 0xffff0000, v164
    v_add_f32 v172, v172, v173
    v_mfma_f32_16x16x32_bf16 v[68:71], v[232:235], a[92:95], v[68:71]
    v_add_f32 v174, v174, v175
    v_cvt_pk_bf16_f32 v168, v172, v174
    v_mfma_f32_16x16x32_bf16 v[72:75], v[228:231], a[92:95], v[72:75]
    buffer_load_dwordx4 v[140:143], v2, s[12:15], s99 offen offset:3072 sc1
    v_mfma_f32_16x16x32_bf16 v[72:75], v[232:235], a[96:99], v[72:75]
    v_lshlrev_b32 v172, 16, v161
    v_lshlrev_b32 v173, 16, v165
    v_mfma_f32_16x16x32_bf16 v[76:79], v[228:231], a[96:99], v[76:79]
    v_and_b32 v174, 0xffff0000, v161
    v_and_b32 v175, 0xffff0000, v165
    v_mfma_f32_16x16x32_bf16 v[76:79], v[232:235], a[100:103], v[76:79]
    v_add_f32 v172, v172, v173
    v_add_f32 v174, v174, v175
    v_mfma_f32_16x16x32_bf16 v[48:51], v[236:239], a[76:79], v[48:51]
    buffer_load_dwordx4 a[180:183], v2, s[12:15], s44 offen offset:0 sc1
    v_mfma_f32_16x16x32_bf16 v[48:51], v[240:243], a[80:83], v[48:51]
    v_cvt_pk_bf16_f32 v169, v172, v174
    v_lshlrev_b32 v172, 16, v162
    v_mfma_f32_16x16x32_bf16 v[52:55], v[236:239], a[80:83], v[52:55]
    v_lshlrev_b32 v173, 16, v166
    v_and_b32 v174, 0xffff0000, v162
    v_mfma_f32_16x16x32_bf16 v[52:55], v[240:243], a[84:87], v[52:55]
    buffer_load_dwordx4 a[184:187], v2, s[12:15], s44 offen offset:1024 sc1
    v_mfma_f32_16x16x32_bf16 v[56:59], v[236:239], a[84:87], v[56:59]
    v_and_b32 v175, 0xffff0000, v166
    ds_read_b128 a[20:23], v184 offset:5440
    v_mfma_f32_16x16x32_bf16 v[56:59], v[240:243], a[88:91], v[56:59]
    s_add_u32 m0, s47, 21504
    v_add_f32 v172, v172, v173
    v_mfma_f32_16x16x32_bf16 v[60:63], v[236:239], a[88:91], v[60:63]
    buffer_load_dwordx4 v9, s[4:7], s60 offen lds
    v_mfma_f32_16x16x32_bf16 v[60:63], v[240:243], a[92:95], v[60:63]
    ds_read_b128 a[24:27], v184 offset:6528
    v_add_f32 v174, v174, v175
    v_mfma_f32_16x16x32_bf16 v[64:67], v[236:239], a[92:95], v[64:67]
    ds_read_b128 a[28:31], v184 offset:7616
    v_cvt_pk_bf16_f32 v170, v172, v174
    v_mfma_f32_16x16x32_bf16 v[64:67], v[240:243], a[96:99], v[64:67]
    buffer_load_dwordx4 a[188:191], v2, s[12:15], s44 offen offset:2048 sc1
    v_mfma_f32_16x16x32_bf16 v[68:71], v[236:239], a[96:99], v[68:71]
    ds_read_b128 a[32:35], v185 offset:0
    v_lshlrev_b32 v172, 16, v163
    v_mfma_f32_16x16x32_bf16 v[68:71], v[240:243], a[100:103], v[68:71]
    s_waitcnt lgkmcnt(9)
    v_lshlrev_b32 v180, 16, v176
    v_mfma_f32_16x16x32_bf16 v[72:75], v[236:239], a[100:103], v[72:75]
    ds_read_b128 a[36:39], v185 offset:1088
    v_lshlrev_b32 v173, 16, v167
    v_mfma_f32_16x16x32_bf16 v[72:75], v[240:243], a[104:107], v[72:75]
    buffer_load_dwordx4 a[192:195], v2, s[12:15], s44 offen offset:3072 sc1
    v_mfma_f32_16x16x32_bf16 v[76:79], v[236:239], a[104:107], v[76:79]
    s_add_u32 s44, s44, 4096
    v_lshlrev_b32 v181, 16, v177
    v_mfma_f32_16x16x32_bf16 v[76:79], v[240:243], a[108:111], v[76:79]
    ds_read_b128 a[40:43], v185 offset:2176
    v_and_b32 v174, 0xffff0000, v163
    v_mfma_f32_16x16x32_bf16 v[48:51], v[244:247], a[84:87], v[48:51]
    buffer_load_dwordx4 a[196:199], v2, s[12:15], s44 offen offset:0 sc1
    v_mfma_f32_16x16x32_bf16 v[52:55], v[244:247], a[88:91], v[52:55]
    v_and_b32 v182, 0xffff0000, v176
    ds_read_b128 a[44:47], v185 offset:3264
    v_mfma_f32_16x16x32_bf16 v[56:59], v[244:247], a[92:95], v[56:59]
    buffer_load_dwordx2 v[150:151], v149, s[32:35], 0 offen offset:0 sc1
    v_mfma_f32_16x16x32_bf16 v[60:63], v[244:247], a[96:99], v[60:63]
    buffer_load_dwordx4 a[200:203], v2, s[12:15], s44 offen offset:1024 sc1
    v_mfma_f32_16x16x32_bf16 v[64:67], v[244:247], a[100:103], v[64:67]
    v_and_b32 v175, 0xffff0000, v167
    v_and_b32 v183, 0xffff0000, v177
    v_mfma_f32_16x16x32_bf16 v[68:71], v[244:247], a[104:107], v[68:71]
    ds_read_b128 a[48:51], v185 offset:4352
    v_add_f32 v172, v172, v173
    v_mfma_f32_16x16x32_bf16 v[72:75], v[244:247], a[108:111], v[72:75]
    buffer_load_dwordx4 a[204:207], v2, s[12:15], s44 offen offset:2048 sc1
    v_mfma_f32_16x16x32_bf16 v[76:79], v[244:247], a[112:115], v[76:79]
    v_add_f32 v180, v180, v181
    ds_read_b128 a[52:55], v185 offset:5440
    s_waitcnt vmcnt(15) lgkmcnt(0)
    v_mfma_f32_16x16x32_bf16 v[80:83], v[112:115], a[120:123], v[80:83]
    v_add_f32 v174, v174, v175
    v_add_f32 v182, v182, v183
    v_mfma_f32_16x16x32_bf16 v[80:83], v[116:119], a[124:127], v[80:83]
    buffer_load_dwordx4 a[208:211], v2, s[12:15], s44 offen offset:3072 sc1
    v_mfma_f32_16x16x32_bf16 v[84:87], v[112:115], a[124:127], v[84:87]
    s_add_u32 s44, s44, 4096
    ds_read_b128 a[56:59], v185 offset:6528
    v_mfma_f32_16x16x32_bf16 v[84:87], v[116:119], a[128:131], v[84:87]
    s_add_u32 m0, s47, 25600
    v_cvt_pk_bf16_f32 v171, v172, v174
    v_mfma_f32_16x16x32_bf16 v[88:91], v[112:115], a[128:131], v[88:91]
    buffer_load_dwordx4 v10, s[4:7], s60 offen lds
    v_mfma_f32_16x16x32_bf16 v[88:91], v[116:119], a[132:135], v[88:91]
    v_cvt_pk_bf16_f32 v178, v180, v182
    ds_write_b128 v5, v[168:171] offset:34816
    v_mfma_f32_16x16x32_bf16 v[92:95], v[112:115], a[132:135], v[92:95]
    ds_write_b32 v7, v178 offset:34816
    v_mfma_f32_16x16x32_bf16 v[92:95], v[116:119], a[136:139], v[92:95]
    v_mfma_f32_16x16x32_bf16 v[96:99], v[112:115], a[136:139], v[96:99]
    buffer_load_dwordx4 a[212:215], v2, s[12:15], s44 offen offset:0 sc1
    v_mfma_f32_16x16x32_bf16 v[96:99], v[116:119], a[140:143], v[96:99]
    v_mfma_f32_16x16x32_bf16 v[100:103], v[112:115], a[140:143], v[100:103]
    v_and_b32 v13, 15, v1
    s_cmp_eq_u32 s38, 31
    s_cselect_b32 s64, 5, 16
    s_cselect_b32 s66, 5, 15
    v_mfma_f32_16x16x32_bf16 v[100:103], v[116:119], a[144:147], v[100:103]
    buffer_load_dwordx4 a[216:219], v2, s[12:15], s44 offen offset:1024 sc1
    v_mfma_f32_16x16x32_bf16 v[104:107], v[112:115], a[144:147], v[104:107]
    v_cmp_gt_u32 s[64:65], s64, v13
    v_cmp_gt_u32 s[66:67], s66, v13
    v_mfma_f32_16x16x32_bf16 v[104:107], v[116:119], a[148:151], v[104:107]
    s_add_u32 m0, s47, 29696
    s_mov_b32 s68, 0xaaaaaaaa
    v_mfma_f32_16x16x32_bf16 v[108:111], v[112:115], a[148:151], v[108:111]
    buffer_load_dwordx4 v11, s[4:7], s60 offen lds
    v_mfma_f32_16x16x32_bf16 v[108:111], v[116:119], a[152:155], v[108:111]
    s_waitcnt vmcnt(18)
    s_mov_b32 s69, 0xaaaaaaaa
    v_mfma_f32_16x16x32_bf16 v[80:83], v[120:123], a[128:131], v[80:83]
    v_cmp_gt_u32 vcc, 8, v13
    v_mov_b32 v247, s42
    v_mfma_f32_16x16x32_bf16 v[80:83], v[124:127], a[132:135], v[80:83]
    buffer_load_dwordx4 a[220:223], v2, s[12:15], s44 offen offset:2048 sc1
    v_mfma_f32_16x16x32_bf16 v[84:87], v[120:123], a[132:135], v[84:87]
    v_mov_b32 v15, s41
    v_cndmask_b32 v247, v247, v15, vcc
    v_mfma_f32_16x16x32_bf16 v[84:87], v[124:127], a[136:139], v[84:87]
    v_lshrrev_b32 v248, 4, v1
    v_lshlrev_b32 v248, 6, v248
    v_mfma_f32_16x16x32_bf16 v[88:91], v[120:123], a[136:139], v[88:91]
    buffer_load_dwordx4 a[224:227], v2, s[12:15], s44 offen offset:3072 sc1
    v_mfma_f32_16x16x32_bf16 v[88:91], v[124:127], a[140:143], v[88:91]
    s_add_u32 s44, s44, 4096
    v_and_b32 v15, 1, v13
    v_mfma_f32_16x16x32_bf16 v[92:95], v[120:123], a[140:143], v[92:95]
    v_lshl_add_u32 v248, v15, 4, v248
    v_bfe_u32 v15, v13, 2, 1
    v_mfma_f32_16x16x32_bf16 v[92:95], v[124:127], a[144:147], v[92:95]
    buffer_load_dwordx4 a[228:231], v2, s[12:15], s44 offen offset:0 sc1
    v_mfma_f32_16x16x32_bf16 v[96:99], v[120:123], a[144:147], v[96:99]
    v_lshl_add_u32 v248, v15, 5, v248
    v_lshrrev_b32 v15, 3, v13
    v_mfma_f32_16x16x32_bf16 v[96:99], v[124:127], a[148:151], v[96:99]
    v_lshl_add_u32 v248, v15, 3, v248
    v_bfe_u32 v15, v13, 1, 1
    v_mfma_f32_16x16x32_bf16 v[100:103], v[120:123], a[148:151], v[100:103]
    v_lshl_add_u32 v248, v15, 30, v248
    s_lshl_b32 s62, s36, 4
    v_mfma_f32_16x16x32_bf16 v[100:103], v[124:127], a[152:155], v[100:103]
    buffer_load_dwordx4 a[232:235], v2, s[12:15], s44 offen offset:1024 sc1
    v_mfma_f32_16x16x32_bf16 v[104:107], v[120:123], a[152:155], v[104:107]
    s_add_u32 s62, s62, s40
    s_lshl_b32 s62, s62, 13
    v_mfma_f32_16x16x32_bf16 v[104:107], v[124:127], a[156:159], v[104:107]
    s_add_u32 s62, s62, 1048576
    s_lshl_b32 s63, s38, 8
    v_mfma_f32_16x16x32_bf16 v[108:111], v[120:123], a[156:159], v[108:111]
    buffer_load_dwordx4 a[236:239], v2, s[12:15], s44 offen offset:2048 sc1
    v_mfma_f32_16x16x32_bf16 v[108:111], v[124:127], a[160:163], v[108:111]
    s_waitcnt vmcnt(21)
    s_add_u32 s63, s63, s62
    v_mfma_f32_16x16x32_bf16 v[80:83], v[128:131], a[136:139], v[80:83]
    v_mfma_f32_16x16x32_bf16 v[80:83], v[132:135], a[140:143], v[80:83]
    buffer_load_dwordx4 a[240:243], v2, s[12:15], s44 offen offset:3072 sc1
L_pg1:
    s_cbranch_execz L_tret
    v_mfma_f32_16x16x32_bf16 v[84:87], v[128:131], a[140:143], v[84:87]
    s_add_u32 s44, s44, 4096
    v_mfma_f32_16x16x32_bf16 v[84:87], v[132:135], a[144:147], v[84:87]
    s_add_u32 m0, s58, 17408
    v_mfma_f32_16x16x32_bf16 v[88:91], v[128:131], a[144:147], v[88:91]
    buffer_load_dword v12, s[4:7], s60 offen lds
    v_mfma_f32_16x16x32_bf16 v[88:91], v[132:135], a[148:151], v[88:91]
    v_mfma_f32_16x16x32_bf16 v[92:95], v[128:131], a[148:151], v[92:95]
    v_mfma_f32_16x16x32_bf16 v[92:95], v[132:135], a[152:155], v[92:95]
    v_mfma_f32_16x16x32_bf16 v[96:99], v[128:131], a[152:155], v[96:99]
    buffer_load_dwordx4 v[112:115], v2, s[12:15], s44 offen offset:0 sc1
    v_mfma_f32_16x16x32_bf16 v[96:99], v[132:135], a[156:159], v[96:99]
    v_mfma_f32_16x16x32_bf16 v[100:103], v[128:131], a[156:159], v[100:103]
    v_mfma_f32_16x16x32_bf16 v[100:103], v[132:135], a[160:163], v[100:103]
    buffer_load_dwordx4 v[116:119], v2, s[12:15], s44 offen offset:1024 sc1
    v_mfma_f32_16x16x32_bf16 v[104:107], v[128:131], a[160:163], v[104:107]
    v_mfma_f32_16x16x32_bf16 v[104:107], v[132:135], a[164:167], v[104:107]
    v_mfma_f32_16x16x32_bf16 v[108:111], v[128:131], a[164:167], v[108:111]
    buffer_load_dwordx4 v[120:123], v2, s[12:15], s44 offen offset:2048 sc1
    v_mfma_f32_16x16x32_bf16 v[108:111], v[132:135], a[168:171], v[108:111]
    s_waitcnt vmcnt(24)
    v_mfma_f32_16x16x32_bf16 v[80:83], v[136:139], a[144:147], v[80:83]
    v_mfma_f32_16x16x32_bf16 v[80:83], v[140:143], a[148:151], v[80:83]
    v_mfma_f32_16x16x32_bf16 v[84:87], v[136:139], a[148:151], v[84:87]
    buffer_load_dwordx4 v[124:127], v2, s[12:15], s44 offen offset:3072 sc1
    v_mfma_f32_16x16x32_bf16 v[84:87], v[140:143], a[152:155], v[84:87]
    s_add_u32 s44, s44, 4096
    v_mfma_f32_16x16x32_bf16 v[88:91], v[136:139], a[152:155], v[88:91]
    v_mfma_f32_16x16x32_bf16 v[88:91], v[140:143], a[156:159], v[88:91]
    buffer_load_dwordx4 v[128:131], v2, s[12:15], s44 offen offset:0 sc1
    v_mfma_f32_16x16x32_bf16 v[92:95], v[136:139], a[156:159], v[92:95]
    v_mfma_f32_16x16x32_bf16 v[92:95], v[140:143], a[160:163], v[92:95]
    v_mfma_f32_16x16x32_bf16 v[96:99], v[136:139], a[160:163], v[96:99]
    buffer_load_dwordx4 v[132:135], v2, s[12:15], s44 offen offset:1024 sc1
    v_mfma_f32_16x16x32_bf16 v[96:99], v[140:143], a[164:167], v[96:99]
    s_waitcnt vmcnt(20)
    v_cmp_eq_u32 vcc, s41, v150
    v_mfma_f32_16x16x32_bf16 v[100:103], v[136:139], a[164:167], v[100:103]
    v_cmp_eq_u32 s[50:51], s42, v151
    v_mfma_f32_16x16x32_bf16 v[100:103], v[140:143], a[168:171], v[100:103]
    v_mfma_f32_16x16x32_bf16 v[104:107], v[136:139], a[168:171], v[104:107]
    s_and_b64 vcc, vcc, s[50:51]
    s_andn2_b64 vcc, -1, vcc
    s_cbranch_scc1 L_spinB
L_spinB_ret:
    s_xor_b32 s47, s47, 65536
    s_xor_b32 s58, s58, 65536
    v_mfma_f32_16x16x32_bf16 v[104:107], v[140:143], a[172:175], v[104:107]
    s_add_u32 s45, s45, 64
    s_add_u32 s60, s60, 64
    v_mfma_f32_16x16x32_bf16 v[108:111], v[136:139], a[172:175], v[108:111]
    v_mfma_f32_16x16x32_bf16 v[108:111], v[140:143], a[176:179], v[108:111]
L_loop:
    s_waitcnt vmcnt(24) lgkmcnt(0)
    v_mfma_f32_16x16x32_bf16 v[16:19], a[180:183], a[0:3], v[16:19]
    s_cmp_eq_u32 s46, 1
    s_cselect_b32 s6, 0, s6
    v_mfma_f32_16x16x32_bf16 v[16:19], a[184:187], a[4:7], v[16:19]
    buffer_load_dwordx4 v[136:139], v2, s[12:15], s44 offen offset:2048 sc1
    v_mfma_f32_16x16x32_bf16 v[20:23], a[180:183], a[4:7], v[20:23]
    ds_read_b128 v[160:163], v186 offset:9792
    v_mfma_f32_16x16x32_bf16 v[20:23], a[184:187], a[8:11], v[20:23]
    ds_read_b128 v[164:167], v6 offset:0
    v_mfma_f32_16x16x32_bf16 v[24:27], a[180:183], a[8:11], v[24:27]
    ds_read_b128 a[60:63], v184 offset:8704
    v_mfma_f32_16x16x32_bf16 v[24:27], a[184:187], a[12:15], v[24:27]
    ds_read_b128 a[64:67], v184 offset:9792
    v_mfma_f32_16x16x32_bf16 v[28:31], a[180:183], a[12:15], v[28:31]
    ds_read_b128 a[68:71], v184 offset:10880
    v_mfma_f32_16x16x32_bf16 v[28:31], a[184:187], a[16:19], v[28:31]
    ds_read_b128 a[72:75], v184 offset:11968
    v_mfma_f32_16x16x32_bf16 v[32:35], a[180:183], a[16:19], v[32:35]
    s_waitcnt lgkmcnt(4)
    v_mfma_f32_16x16x32_bf16 v[32:35], a[184:187], a[20:23], v[32:35]
    buffer_load_dwordx4 v[140:143], v2, s[12:15], s44 offen offset:3072 sc1
    v_mfma_f32_16x16x32_bf16 v[36:39], a[180:183], a[20:23], v[36:39]
    s_add_u32 s44, s44, 4096
    v_lshlrev_b32 v172, 16, v160
    v_mfma_f32_16x16x32_bf16 v[36:39], a[184:187], a[24:27], v[36:39]
    v_lshlrev_b32 v173, 16, v164
    v_mfma_f32_16x16x32_bf16 v[40:43], a[180:183], a[24:27], v[40:43]
    s_add_u32 m0, s47, 0
    v_and_b32 v174, 0xffff0000, v160
    v_mfma_f32_16x16x32_bf16 v[40:43], a[184:187], a[28:31], v[40:43]
    buffer_load_dwordx4 v8, s[4:7], s45 offen lds
    v_mfma_f32_16x16x32_bf16 v[44:47], a[180:183], a[28:31], v[44:47]
    ds_read_b128 a[76:79], v184 offset:13056
    v_mfma_f32_16x16x32_bf16 v[44:47], a[184:187], a[32:35], v[44:47]
    s_waitcnt vmcnt(24)
    v_and_b32 v175, 0xffff0000, v164
    v_mfma_f32_16x16x32_bf16 v[16:19], a[188:191], a[8:11], v[16:19]
    v_add_f32 v172, v172, v173
    v_mfma_f32_16x16x32_bf16 v[16:19], a[192:195], a[12:15], v[16:19]
    buffer_load_dwordx4 a[180:183], v2, s[12:15], s44 offen offset:0 sc1
    v_mfma_f32_16x16x32_bf16 v[20:23], a[188:191], a[12:15], v[20:23]
    v_add_f32 v174, v174, v175
    v_mfma_f32_16x16x32_bf16 v[20:23], a[192:195], a[16:19], v[20:23]
    ds_read_b128 a[80:83], v184 offset:14144
    v_mfma_f32_16x16x32_bf16 v[24:27], a[188:191], a[16:19], v[24:27]
    v_cvt_pk_bf16_f32 v168, v172, v174
    v_mfma_f32_16x16x32_bf16 v[24:27], a[192:195], a[20:23], v[24:27]
    v_lshlrev_b32 v172, 16, v161
    v_mfma_f32_16x16x32_bf16 v[28:31], a[188:191], a[20:23], v[28:31]
    v_lshlrev_b32 v173, 16, v165
    v_mfma_f32_16x16x32_bf16 v[28:31], a[192:195], a[24:27], v[28:31]
    ds_read_b128 a[84:87], v184 offset:15232
    v_mfma_f32_16x16x32_bf16 v[32:35], a[188:191], a[24:27], v[32:35]
    buffer_load_dwordx4 a[184:187], v2, s[12:15], s44 offen offset:1024 sc1
    v_mfma_f32_16x16x32_bf16 v[32:35], a[192:195], a[28:31], v[32:35]
    v_and_b32 v174, 0xffff0000, v161
    v_mfma_f32_16x16x32_bf16 v[36:39], a[188:191], a[28:31], v[36:39]
    v_and_b32 v175, 0xffff0000, v165
    v_mfma_f32_16x16x32_bf16 v[36:39], a[192:195], a[32:35], v[36:39]
    v_add_f32 v172, v172, v173
    v_mfma_f32_16x16x32_bf16 v[40:43], a[188:191], a[32:35], v[40:43]
    s_add_u32 m0, s47, 4096
    ds_read_b128 a[88:91], v184 offset:16320
    v_mfma_f32_16x16x32_bf16 v[40:43], a[192:195], a[36:39], v[40:43]
    buffer_load_dwordx4 v9, s[4:7], s45 offen lds
    v_mfma_f32_16x16x32_bf16 v[44:47], a[188:191], a[36:39], v[44:47]
    v_add_f32 v174, v174, v175
    v_mfma_f32_16x16x32_bf16 v[44:47], a[192:195], a[40:43], v[44:47]
    s_waitcnt vmcnt(25)
    v_cvt_pk_bf16_f32 v169, v172, v174
    v_mfma_f32_16x16x32_bf16 v[16:19], a[196:199], a[16:19], v[16:19]
    v_lshlrev_b32 v172, 16, v162
    v_mfma_f32_16x16x32_bf16 v[16:19], a[200:203], a[20:23], v[16:19]
    buffer_load_dwordx4 a[188:191], v2, s[12:15], s44 offen offset:2048 sc1
    v_mfma_f32_16x16x32_bf16 v[20:23], a[196:199], a[20:23], v[20:23]
    ds_read_b128 a[92:95], v185 offset:8704
    v_mfma_f32_16x16x32_bf16 v[20:23], a[200:203], a[24:27], v[20:23]
    v_lshlrev_b32 v173, 16, v166
    v_mfma_f32_16x16x32_bf16 v[24:27], a[196:199], a[24:27], v[24:27]
    v_and_b32 v174, 0xffff0000, v162
    v_mfma_f32_16x16x32_bf16 v[24:27], a[200:203], a[28:31], v[24:27]
    v_and_b32 v175, 0xffff0000, v166
    v_mfma_f32_16x16x32_bf16 v[28:31], a[196:199], a[28:31], v[28:31]
    ds_read_b128 a[96:99], v185 offset:9792
    v_mfma_f32_16x16x32_bf16 v[28:31], a[200:203], a[32:35], v[28:31]
    v_add_f32 v172, v172, v173
    v_mfma_f32_16x16x32_bf16 v[32:35], a[196:199], a[32:35], v[32:35]
    buffer_load_dwordx4 a[192:195], v2, s[12:15], s44 offen offset:3072 sc1
    v_mfma_f32_16x16x32_bf16 v[32:35], a[200:203], a[36:39], v[32:35]
    s_add_u32 s44, s44, 4096
    v_add_f32 v174, v174, v175
    v_mfma_f32_16x16x32_bf16 v[36:39], a[196:199], a[36:39], v[36:39]
    v_cvt_pk_bf16_f32 v170, v172, v174
    v_mfma_f32_16x16x32_bf16 v[36:39], a[200:203], a[40:43], v[36:39]
    ds_read_b128 a[100:103], v185 offset:10880
    v_mfma_f32_16x16x32_bf16 v[40:43], a[196:199], a[40:43], v[40:43]
    v_lshlrev_b32 v172, 16, v163
    v_mfma_f32_16x16x32_bf16 v[40:43], a[200:203], a[44:47], v[40:43]
    v_lshlrev_b32 v173, 16, v167
    v_mfma_f32_16x16x32_bf16 v[44:47], a[196:199], a[44:47], v[44:47]
    v_and_b32 v174, 0xffff0000, v163
    v_mfma_f32_16x16x32_bf16 v[44:47], a[200:203], a[48:51], v[44:47]
    s_waitcnt vmcnt(25)
    ds_read_b128 a[104:107], v185 offset:11968
    v_mfma_f32_16x16x32_bf16 v[16:19], a[204:207], a[24:27], v[16:19]
    v_and_b32 v175, 0xffff0000, v167
    v_mfma_f32_16x16x32_bf16 v[16:19], a[208:211], a[28:31], v[16:19]
    buffer_load_dwordx4 a[196:199], v2, s[12:15], s44 offen offset:0 sc1
    v_mfma_f32_16x16x32_bf16 v[20:23], a[204:207], a[28:31], v[20:23]
    v_add_f32 v172, v172, v173
    v_mfma_f32_16x16x32_bf16 v[20:23], a[208:211], a[32:35], v[20:23]
    v_add_f32 v174, v174, v175
    v_mfma_f32_16x16x32_bf16 v[24:27], a[204:207], a[32:35], v[24:27]
    ds_read_b128 a[108:111], v185 offset:13056
    v_mfma_f32_16x16x32_bf16 v[24:27], a[208:211], a[36:39], v[24:27]
    v_cvt_pk_bf16_f32 v171, v172, v174
    v_mfma_f32_16x16x32_bf16 v[28:31], a[204:207], a[36:39], v[28:31]
    ds_read_b128 a[112:115], v185 offset:14144
    v_mfma_f32_16x16x32_bf16 v[28:31], a[208:211], a[40:43], v[28:31]
    ds_read_b128 a[116:119], v185 offset:15232
    v_mfma_f32_16x16x32_bf16 v[32:35], a[204:207], a[40:43], v[32:35]
    buffer_load_dwordx4 a[200:203], v2, s[12:15], s44 offen offset:1024 sc1
    v_mfma_f32_16x16x32_bf16 v[32:35], a[208:211], a[44:47], v[32:35]
    ds_write_b128 v5, v[168:171] offset:35904
    v_mfma_f32_16x16x32_bf16 v[36:39], a[204:207], a[44:47], v[36:39]
    v_mfma_f32_16x16x32_bf16 v[36:39], a[208:211], a[48:51], v[36:39]
    v_mfma_f32_16x16x32_bf16 v[40:43], a[204:207], a[48:51], v[40:43]
    v_mfma_f32_16x16x32_bf16 v[40:43], a[208:211], a[52:55], v[40:43]
    v_mfma_f32_16x16x32_bf16 v[44:47], a[204:207], a[52:55], v[44:47]
    v_mfma_f32_16x16x32_bf16 v[44:47], a[208:211], a[56:59], v[44:47]
    s_waitcnt vmcnt(16) lgkmcnt(0)
    s_barrier
    v_mfma_f32_16x16x32_bf16 v[48:51], a[212:215], a[60:63], v[48:51]
    ds_read_b32 v176, v187 offset:26112
    v_mfma_f32_16x16x32_bf16 v[48:51], a[216:219], a[64:67], v[48:51]
    buffer_load_dwordx4 a[204:207], v2, s[12:15], s44 offen offset:2048 sc1
    v_mfma_f32_16x16x32_bf16 v[52:55], a[212:215], a[64:67], v[52:55]
    v_mfma_f32_16x16x32_bf16 v[52:55], a[216:219], a[68:71], v[52:55]
    ds_read_b32 v177, v187 offset:18496
    v_mfma_f32_16x16x32_bf16 v[56:59], a[212:215], a[68:71], v[56:59]
    ds_read_b128 a[120:123], v3 offset:34816
    v_mfma_f32_16x16x32_bf16 v[56:59], a[216:219], a[72:75], v[56:59]
    v_mfma_f32_16x16x32_bf16 v[60:63], a[212:215], a[72:75], v[60:63]
    ds_read_b128 a[124:127], v3 offset:35904
    v_mfma_f32_16x16x32_bf16 v[60:63], a[216:219], a[76:79], v[60:63]
    ds_read_b128 a[128:131], v3 offset:36992
    v_mfma_f32_16x16x32_bf16 v[64:67], a[212:215], a[76:79], v[64:67]
    v_mfma_f32_16x16x32_bf16 v[64:67], a[216:219], a[80:83], v[64:67]
    buffer_load_dwordx4 a[208:211], v2, s[12:15], s44 offen offset:3072 sc1
    v_mfma_f32_16x16x32_bf16 v[68:71], a[212:215], a[80:83], v[68:71]
    s_add_u32 s44, s44, 4096
    v_mfma_f32_16x16x32_bf16 v[68:71], a[216:219], a[84:87], v[68:71]
    ds_read_b128 a[132:135], v3 offset:38080
    v_mfma_f32_16x16x32_bf16 v[72:75], a[212:215], a[84:87], v[72:75]
    s_add_u32 m0, s47, 8192
    v_mfma_f32_16x16x32_bf16 v[72:75], a[216:219], a[88:91], v[72:75]
    buffer_load_dwordx4 v10, s[4:7], s45 offen lds
    v_mfma_f32_16x16x32_bf16 v[76:79], a[212:215], a[88:91], v[76:79]
    v_mfma_f32_16x16x32_bf16 v[76:79], a[216:219], a[92:95], v[76:79]
    s_waitcnt vmcnt(24)
    v_mfma_f32_16x16x32_bf16 v[48:51], a[220:223], a[68:71], v[48:51]
    s_waitcnt lgkmcnt(4)
    v_mfma_f32_16x16x32_bf16 v[48:51], a[224:227], a[72:75], v[48:51]
    buffer_load_dwordx4 a[212:215], v2, s[12:15], s44 offen offset:0 sc1
    v_mfma_f32_16x16x32_bf16 v[52:55], a[220:223], a[72:75], v[52:55]
    v_lshlrev_b32 v180, 16, v176
    v_mfma_f32_16x16x32_bf16 v[52:55], a[224:227], a[76:79], v[52:55]
    v_mfma_f32_16x16x32_bf16 v[56:59], a[220:223], a[76:79], v[56:59]
    ds_read_b128 a[136:139], v3 offset:39168
    v_mfma_f32_16x16x32_bf16 v[56:59], a[224:227], a[80:83], v[56:59]
    v_lshlrev_b32 v181, 16, v177
    v_mfma_f32_16x16x32_bf16 v[60:63], a[220:223], a[80:83], v[60:63]
    v_mfma_f32_16x16x32_bf16 v[60:63], a[224:227], a[84:87], v[60:63]
    ds_read_b128 a[140:143], v3 offset:40256
    v_mfma_f32_16x16x32_bf16 v[64:67], a[220:223], a[84:87], v[64:67]
    buffer_load_dwordx4 a[216:219], v2, s[12:15], s44 offen offset:1024 sc1
    v_mfma_f32_16x16x32_bf16 v[64:67], a[224:227], a[88:91], v[64:67]
    v_mfma_f32_16x16x32_bf16 v[68:71], a[220:223], a[88:91], v[68:71]
    v_and_b32 v182, 0xffff0000, v176
    v_mfma_f32_16x16x32_bf16 v[68:71], a[224:227], a[92:95], v[68:71]
    ds_read_b128 a[144:147], v3 offset:41344
    v_mfma_f32_16x16x32_bf16 v[72:75], a[220:223], a[92:95], v[72:75]
    s_add_u32 m0, s47, 12288
    v_mfma_f32_16x16x32_bf16 v[72:75], a[224:227], a[96:99], v[72:75]
    buffer_load_dwordx4 v11, s[4:7], s45 offen lds
    v_mfma_f32_16x16x32_bf16 v[76:79], a[220:223], a[96:99], v[76:79]
    v_mfma_f32_16x16x32_bf16 v[76:79], a[224:227], a[100:103], v[76:79]
    s_waitcnt vmcnt(25)
    v_mfma_f32_16x16x32_bf16 v[48:51], a[228:231], a[76:79], v[48:51]
    v_and_b32 v183, 0xffff0000, v177
    v_mfma_f32_16x16x32_bf16 v[48:51], a[232:235], a[80:83], v[48:51]
    buffer_load_dwordx4 a[220:223], v2, s[12:15], s44 offen offset:2048 sc1
    v_mfma_f32_16x16x32_bf16 v[52:55], a[228:231], a[80:83], v[52:55]
    ds_read_b128 a[148:151], v3 offset:42432
    v_mfma_f32_16x16x32_bf16 v[52:55], a[232:235], a[84:87], v[52:55]
    v_mfma_f32_16x16x32_bf16 v[56:59], a[228:231], a[84:87], v[56:59]
    v_add_f32 v180, v180, v181
    v_mfma_f32_16x16x32_bf16 v[56:59], a[232:235], a[88:91], v[56:59]
    v_mfma_f32_16x16x32_bf16 v[60:63], a[228:231], a[88:91], v[60:63]
    ds_read_b128 a[152:155], v4 offset:34816
    v_mfma_f32_16x16x32_bf16 v[60:63], a[232:235], a[92:95], v[60:63]
    v_add_f32 v182, v182, v183
    v_mfma_f32_16x16x32_bf16 v[64:67], a[228:231], a[92:95], v[64:67]
    buffer_load_dwordx4 a[224:227], v2, s[12:15], s44 offen offset:3072 sc1
    v_mfma_f32_16x16x32_bf16 v[64:67], a[232:235], a[96:99], v[64:67]
    s_add_u32 s44, s44, 4096
    v_mfma_f32_16x16x32_bf16 v[68:71], a[228:231], a[96:99], v[68:71]
    v_mfma_f32_16x16x32_bf16 v[68:71], a[232:235], a[100:103], v[68:71]
    ds_read_b128 a[156:159], v4 offset:35904
    v_mfma_f32_16x16x32_bf16 v[72:75], a[228:231], a[100:103], v[72:75]
    v_cvt_pk_bf16_f32 v178, v180, v182
    v_mfma_f32_16x16x32_bf16 v[72:75], a[232:235], a[104:107], v[72:75]
    v_mfma_f32_16x16x32_bf16 v[76:79], a[228:231], a[104:107], v[76:79]
    ds_read_b128 a[160:163], v4 offset:36992
    v_mfma_f32_16x16x32_bf16 v[76:79], a[232:235], a[108:111], v[76:79]
    s_waitcnt vmcnt(25)
    v_mfma_f32_16x16x32_bf16 v[48:51], a[236:239], a[84:87], v[48:51]
    v_mfma_f32_16x16x32_bf16 v[48:51], a[240:243], a[88:91], v[48:51]
    buffer_load_dwordx4 a[228:231], v2, s[12:15], s44 offen offset:0 sc1
    v_mfma_f32_16x16x32_bf16 v[52:55], a[236:239], a[88:91], v[52:55]
    ds_read_b128 a[164:167], v4 offset:38080
    v_mfma_f32_16x16x32_bf16 v[52:55], a[240:243], a[92:95], v[52:55]
    ds_read_b128 a[168:171], v4 offset:39168
    v_mfma_f32_16x16x32_bf16 v[56:59], a[236:239], a[92:95], v[56:59]
    v_mfma_f32_16x16x32_bf16 v[56:59], a[240:243], a[96:99], v[56:59]
    ds_read_b128 a[172:175], v4 offset:40256
    v_mfma_f32_16x16x32_bf16 v[60:63], a[236:239], a[96:99], v[60:63]
    ds_read_b128 a[176:179], v4 offset:41344
    v_mfma_f32_16x16x32_bf16 v[60:63], a[240:243], a[100:103], v[60:63]
    v_mfma_f32_16x16x32_bf16 v[64:67], a[236:239], a[100:103], v[64:67]
    buffer_load_dwordx4 a[232:235], v2, s[12:15], s44 offen offset:1024 sc1
    v_mfma_f32_16x16x32_bf16 v[64:67], a[240:243], a[104:107], v[64:67]
    ds_write_b32 v7, v178 offset:43520
    v_mfma_f32_16x16x32_bf16 v[68:71], a[236:239], a[104:107], v[68:71]
    v_mfma_f32_16x16x32_bf16 v[68:71], a[240:243], a[108:111], v[68:71]
    v_mfma_f32_16x16x32_bf16 v[72:75], a[236:239], a[108:111], v[72:75]
    v_mfma_f32_16x16x32_bf16 v[72:75], a[240:243], a[112:115], v[72:75]
    v_mfma_f32_16x16x32_bf16 v[76:79], a[236:239], a[112:115], v[76:79]
    v_mfma_f32_16x16x32_bf16 v[76:79], a[240:243], a[116:119], v[76:79]
    s_waitcnt vmcnt(24) lgkmcnt(0)
    v_mfma_f32_16x16x32_bf16 v[80:83], v[112:115], a[120:123], v[80:83]
    ds_read_b128 v[160:163], v186 offset:26112
    v_mfma_f32_16x16x32_bf16 v[80:83], v[116:119], a[124:127], v[80:83]
    buffer_load_dwordx4 a[236:239], v2, s[12:15], s44 offen offset:2048 sc1
    v_mfma_f32_16x16x32_bf16 v[84:87], v[112:115], a[124:127], v[84:87]
    ds_read_b128 v[164:167], v186 offset:18496
    v_mfma_f32_16x16x32_bf16 v[84:87], v[116:119], a[128:131], v[84:87]
    ds_read_b128 a[0:3], v184 offset:17408
    v_mfma_f32_16x16x32_bf16 v[88:91], v[112:115], a[128:131], v[88:91]
    ds_read_b128 a[4:7], v184 offset:18496
    v_mfma_f32_16x16x32_bf16 v[88:91], v[116:119], a[132:135], v[88:91]
    ds_read_b128 a[8:11], v184 offset:19584
    v_mfma_f32_16x16x32_bf16 v[92:95], v[112:115], a[132:135], v[92:95]
    ds_read_b128 a[12:15], v184 offset:20672
    v_mfma_f32_16x16x32_bf16 v[92:95], v[116:119], a[136:139], v[92:95]
    s_waitcnt lgkmcnt(4)
    v_mfma_f32_16x16x32_bf16 v[96:99], v[112:115], a[136:139], v[96:99]
    v_lshlrev_b32 v172, 16, v160
    v_mfma_f32_16x16x32_bf16 v[96:99], v[116:119], a[140:143], v[96:99]
    v_lshlrev_b32 v173, 16, v164
    v_mfma_f32_16x16x32_bf16 v[100:103], v[112:115], a[140:143], v[100:103]
    s_add_u32 s44, s44, 4096
    v_and_b32 v174, 0xffff0000, v160
    v_mfma_f32_16x16x32_bf16 v[100:103], v[116:119], a[144:147], v[100:103]
    ds_read_b128 a[16:19], v184 offset:21760
    v_mfma_f32_16x16x32_bf16 v[104:107], v[112:115], a[144:147], v[104:107]
    s_add_u32 m0, s58, 0
    v_and_b32 v175, 0xffff0000, v164
    v_mfma_f32_16x16x32_bf16 v[104:107], v[116:119], a[148:151], v[104:107]
    buffer_load_dword v12, s[4:7], s45 offen lds
    v_mfma_f32_16x16x32_bf16 v[108:111], v[112:115], a[148:151], v[108:111]
    v_add_f32 v172, v172, v173
    v_mfma_f32_16x16x32_bf16 v[108:111], v[116:119], a[152:155], v[108:111]
    s_waitcnt vmcnt(24)
    v_add_f32 v174, v174, v175
    v_mfma_f32_16x16x32_bf16 v[80:83], v[120:123], a[128:131], v[80:83]
    ds_read_b128 a[20:23], v184 offset:22848
    v_mfma_f32_16x16x32_bf16 v[80:83], v[124:127], a[132:135], v[80:83]
    buffer_load_dwordx4 v[112:115], v2, s[12:15], s44 offen offset:0 sc1
    v_mfma_f32_16x16x32_bf16 v[84:87], v[120:123], a[132:135], v[84:87]
    v_cvt_pk_bf16_f32 v168, v172, v174
    v_mfma_f32_16x16x32_bf16 v[84:87], v[124:127], a[136:139], v[84:87]
    v_lshlrev_b32 v172, 16, v161
    v_mfma_f32_16x16x32_bf16 v[88:91], v[120:123], a[136:139], v[88:91]
    v_lshlrev_b32 v173, 16, v165
    v_mfma_f32_16x16x32_bf16 v[88:91], v[124:127], a[140:143], v[88:91]
    ds_read_b128 a[24:27], v184 offset:23936
    v_mfma_f32_16x16x32_bf16 v[92:95], v[120:123], a[140:143], v[92:95]
    v_and_b32 v174, 0xffff0000, v161
    v_mfma_f32_16x16x32_bf16 v[92:95], v[124:127], a[144:147], v[92:95]
    v_and_b32 v175, 0xffff0000, v165
    v_mfma_f32_16x16x32_bf16 v[96:99], v[120:123], a[144:147], v[96:99]
    buffer_load_dwordx4 v[116:119], v2, s[12:15], s44 offen offset:1024 sc1
    v_mfma_f32_16x16x32_bf16 v[96:99], v[124:127], a[148:151], v[96:99]
    v_add_f32 v172, v172, v173
    v_mfma_f32_16x16x32_bf16 v[100:103], v[120:123], a[148:151], v[100:103]
    ds_read_b128 a[28:31], v184 offset:25024
    v_mfma_f32_16x16x32_bf16 v[100:103], v[124:127], a[152:155], v[100:103]
    v_add_f32 v174, v174, v175
    v_mfma_f32_16x16x32_bf16 v[104:107], v[120:123], a[152:155], v[104:107]
    v_cvt_pk_bf16_f32 v169, v172, v174
    v_mfma_f32_16x16x32_bf16 v[104:107], v[124:127], a[156:159], v[104:107]
    v_lshlrev_b32 v172, 16, v162
    v_mfma_f32_16x16x32_bf16 v[108:111], v[120:123], a[156:159], v[108:111]
    ds_read_b128 a[32:35], v185 offset:17408
    v_mfma_f32_16x16x32_bf16 v[108:111], v[124:127], a[160:163], v[108:111]
    s_waitcnt vmcnt(24)
    v_mfma_f32_16x16x32_bf16 v[80:83], v[128:131], a[136:139], v[80:83]
    v_lshlrev_b32 v173, 16, v166
    v_mfma_f32_16x16x32_bf16 v[80:83], v[132:135], a[140:143], v[80:83]
    buffer_load_dwordx4 v[120:123], v2, s[12:15], s44 offen offset:2048 sc1
    v_mfma_f32_16x16x32_bf16 v[84:87], v[128:131], a[140:143], v[84:87]
    v_and_b32 v174, 0xffff0000, v162
    v_mfma_f32_16x16x32_bf16 v[84:87], v[132:135], a[144:147], v[84:87]
    v_and_b32 v175, 0xffff0000, v166
    v_mfma_f32_16x16x32_bf16 v[88:91], v[128:131], a[144:147], v[88:91]
    ds_read_b128 a[36:39], v185 offset:18496
    v_mfma_f32_16x16x32_bf16 v[88:91], v[132:135], a[148:151], v[88:91]
    v_add_f32 v172, v172, v173
    v_mfma_f32_16x16x32_bf16 v[92:95], v[128:131], a[148:151], v[92:95]
    v_add_f32 v174, v174, v175
    v_mfma_f32_16x16x32_bf16 v[92:95], v[132:135], a[152:155], v[92:95]
    v_cvt_pk_bf16_f32 v170, v172, v174
    v_mfma_f32_16x16x32_bf16 v[96:99], v[128:131], a[152:155], v[96:99]
    buffer_load_dwordx4 v[124:127], v2, s[12:15], s44 offen offset:3072 sc1
    v_mfma_f32_16x16x32_bf16 v[96:99], v[132:135], a[156:159], v[96:99]
    s_add_u32 s44, s44, 4096
    v_mfma_f32_16x16x32_bf16 v[100:103], v[128:131], a[156:159], v[100:103]
    ds_read_b128 a[40:43], v185 offset:19584
    v_mfma_f32_16x16x32_bf16 v[100:103], v[132:135], a[160:163], v[100:103]
    v_lshlrev_b32 v172, 16, v163
    v_mfma_f32_16x16x32_bf16 v[104:107], v[128:131], a[160:163], v[104:107]
    v_lshlrev_b32 v173, 16, v167
    v_mfma_f32_16x16x32_bf16 v[104:107], v[132:135], a[164:167], v[104:107]
    v_and_b32 v174, 0xffff0000, v163
    v_mfma_f32_16x16x32_bf16 v[108:111], v[128:131], a[164:167], v[108:111]
    ds_read_b128 a[44:47], v185 offset:20672
    v_mfma_f32_16x16x32_bf16 v[108:111], v[132:135], a[168:171], v[108:111]
    s_waitcnt vmcnt(24)
    v_mfma_f32_16x16x32_bf16 v[80:83], v[136:139], a[144:147], v[80:83]
    v_and_b32 v175, 0xffff0000, v167
    v_mfma_f32_16x16x32_bf16 v[80:83], v[140:143], a[148:151], v[80:83]
    buffer_load_dwordx4 v[128:131], v2, s[12:15], s44 offen offset:0 sc1
    v_mfma_f32_16x16x32_bf16 v[84:87], v[136:139], a[148:151], v[84:87]
    v_add_f32 v172, v172, v173
    v_mfma_f32_16x16x32_bf16 v[84:87], v[140:143], a[152:155], v[84:87]
    v_add_f32 v174, v174, v175
    v_mfma_f32_16x16x32_bf16 v[88:91], v[136:139], a[152:155], v[88:91]
    ds_read_b128 a[48:51], v185 offset:21760
    v_mfma_f32_16x16x32_bf16 v[88:91], v[140:143], a[156:159], v[88:91]
    v_cvt_pk_bf16_f32 v171, v172, v174
    v_mfma_f32_16x16x32_bf16 v[92:95], v[136:139], a[156:159], v[92:95]
    ds_read_b128 a[52:55], v185 offset:22848
    v_mfma_f32_16x16x32_bf16 v[92:95], v[140:143], a[160:163], v[92:95]
    ds_read_b128 a[56:59], v185 offset:23936
    v_mfma_f32_16x16x32_bf16 v[96:99], v[136:139], a[160:163], v[96:99]
    buffer_load_dwordx4 v[132:135], v2, s[12:15], s44 offen offset:1024 sc1
    v_mfma_f32_16x16x32_bf16 v[96:99], v[140:143], a[164:167], v[96:99]
    ds_write_b128 v5, v[168:171] offset:43520
    v_mfma_f32_16x16x32_bf16 v[100:103], v[136:139], a[164:167], v[100:103]
    v_mfma_f32_16x16x32_bf16 v[100:103], v[140:143], a[168:171], v[100:103]
    v_mfma_f32_16x16x32_bf16 v[104:107], v[136:139], a[168:171], v[104:107]
    v_mfma_f32_16x16x32_bf16 v[104:107], v[140:143], a[172:175], v[104:107]
    v_mfma_f32_16x16x32_bf16 v[108:111], v[136:139], a[172:175], v[108:111]
    v_mfma_f32_16x16x32_bf16 v[108:111], v[140:143], a[176:179], v[108:111]
    s_waitcnt vmcnt(23) lgkmcnt(0)
    v_mfma_f32_16x16x32_bf16 v[16:19], a[180:183], a[0:3], v[16:19]
    ds_read_b128 v[160:163], v186 offset:27200
    v_mfma_f32_16x16x32_bf16 v[16:19], a[184:187], a[4:7], v[16:19]
    buffer_load_dwordx4 v[136:139], v2, s[12:15], s44 offen offset:2048 sc1
    v_mfma_f32_16x16x32_bf16 v[20:23], a[180:183], a[4:7], v[20:23]
    ds_read_b128 v[164:167], v6 offset:17408
    v_mfma_f32_16x16x32_bf16 v[20:23], a[184:187], a[8:11], v[20:23]
    ds_read_b128 a[60:63], v184 offset:26112
    v_mfma_f32_16x16x32_bf16 v[24:27], a[180:183], a[8:11], v[24:27]
    ds_read_b128 a[64:67], v184 offset:27200
    v_mfma_f32_16x16x32_bf16 v[24:27], a[184:187], a[12:15], v[24:27]
    ds_read_b128 a[68:71], v184 offset:28288
    v_mfma_f32_16x16x32_bf16 v[28:31], a[180:183], a[12:15], v[28:31]
    ds_read_b128 a[72:75], v184 offset:29376
    v_mfma_f32_16x16x32_bf16 v[28:31], a[184:187], a[16:19], v[28:31]
    s_waitcnt lgkmcnt(4)
    v_mfma_f32_16x16x32_bf16 v[32:35], a[180:183], a[16:19], v[32:35]
    v_lshlrev_b32 v172, 16, v160
    v_mfma_f32_16x16x32_bf16 v[32:35], a[184:187], a[20:23], v[32:35]
    buffer_load_dwordx4 v[140:143], v2, s[12:15], s44 offen offset:3072 sc1
    v_mfma_f32_16x16x32_bf16 v[36:39], a[180:183], a[20:23], v[36:39]
    s_add_u32 s44, s44, 4096
    v_lshlrev_b32 v173, 16, v164
    v_mfma_f32_16x16x32_bf16 v[36:39], a[184:187], a[24:27], v[36:39]
    v_and_b32 v174, 0xffff0000, v160
    v_mfma_f32_16x16x32_bf16 v[40:43], a[180:183], a[24:27], v[40:43]
    s_add_u32 m0, s47, 17408
    ds_read_b128 a[76:79], v184 offset:30464
    v_mfma_f32_16x16x32_bf16 v[40:43], a[184:187], a[28:31], v[40:43]
    buffer_load_dwordx4 v8, s[4:7], s60 offen lds
    v_mfma_f32_16x16x32_bf16 v[44:47], a[180:183], a[28:31], v[44:47]
    v_and_b32 v175, 0xffff0000, v164
    v_mfma_f32_16x16x32_bf16 v[44:47], a[184:187], a[32:35], v[44:47]
    s_waitcnt vmcnt(23)
    v_add_f32 v172, v172, v173
    v_mfma_f32_16x16x32_bf16 v[16:19], a[188:191], a[8:11], v[16:19]
    v_add_f32 v174, v174, v175
    v_mfma_f32_16x16x32_bf16 v[16:19], a[192:195], a[12:15], v[16:19]
    buffer_load_dwordx4 a[180:183], v2, s[12:15], s44 offen offset:0 sc1
    v_mfma_f32_16x16x32_bf16 v[20:23], a[188:191], a[12:15], v[20:23]
    ds_read_b128 a[80:83], v184 offset:31552
    v_mfma_f32_16x16x32_bf16 v[20:23], a[192:195], a[16:19], v[20:23]
    v_cvt_pk_bf16_f32 v168, v172, v174
    v_mfma_f32_16x16x32_bf16 v[24:27], a[188:191], a[16:19], v[24:27]
    v_lshlrev_b32 v172, 16, v161
    v_mfma_f32_16x16x32_bf16 v[24:27], a[192:195], a[20:23], v[24:27]
    v_lshlrev_b32 v173, 16, v165
    v_mfma_f32_16x16x32_bf16 v[28:31], a[188:191], a[20:23], v[28:31]
    ds_read_b128 a[84:87], v184 offset:32640
    v_mfma_f32_16x16x32_bf16 v[28:31], a[192:195], a[24:27], v[28:31]
    v_and_b32 v174, 0xffff0000, v161
    v_mfma_f32_16x16x32_bf16 v[32:35], a[188:191], a[24:27], v[32:35]
    buffer_load_dwordx4 a[184:187], v2, s[12:15], s44 offen offset:1024 sc1
    v_mfma_f32_16x16x32_bf16 v[32:35], a[192:195], a[28:31], v[32:35]
    v_and_b32 v175, 0xffff0000, v165
    v_mfma_f32_16x16x32_bf16 v[36:39], a[188:191], a[28:31], v[36:39]
    v_add_f32 v172, v172, v173
    v_mfma_f32_16x16x32_bf16 v[36:39], a[192:195], a[32:35], v[36:39]
    ds_read_b128 a[88:91], v184 offset:33728
    v_mfma_f32_16x16x32_bf16 v[40:43], a[188:191], a[32:35], v[40:43]
    s_add_u32 m0, s47, 21504
    v_add_f32 v174, v174, v175
    v_mfma_f32_16x16x32_bf16 v[40:43], a[192:195], a[36:39], v[40:43]
    buffer_load_dwordx4 v9, s[4:7], s60 offen lds
    v_mfma_f32_16x16x32_bf16 v[44:47], a[188:191], a[36:39], v[44:47]
    v_cvt_pk_bf16_f32 v169, v172, v174
    v_mfma_f32_16x16x32_bf16 v[44:47], a[192:195], a[40:43], v[44:47]
    s_waitcnt vmcnt(24)
    v_lshlrev_b32 v172, 16, v162
    v_mfma_f32_16x16x32_bf16 v[16:19], a[196:199], a[16:19], v[16:19]
    ds_read_b128 a[92:95], v185 offset:26112
    v_mfma_f32_16x16x32_bf16 v[16:19], a[200:203], a[20:23], v[16:19]
    buffer_load_dwordx4 a[188:191], v2, s[12:15], s44 offen offset:2048 sc1
    v_mfma_f32_16x16x32_bf16 v[20:23], a[196:199], a[20:23], v[20:23]
    v_lshlrev_b32 v173, 16, v166
    v_mfma_f32_16x16x32_bf16 v[20:23], a[200:203], a[24:27], v[20:23]
    v_and_b32 v174, 0xffff0000, v162
    v_mfma_f32_16x16x32_bf16 v[24:27], a[196:199], a[24:27], v[24:27]
    v_and_b32 v175, 0xffff0000, v166
    v_mfma_f32_16x16x32_bf16 v[24:27], a[200:203], a[28:31], v[24:27]
    ds_read_b128 a[96:99], v185 offset:27200
    v_mfma_f32_16x16x32_bf16 v[28:31], a[196:199], a[28:31], v[28:31]
    v_add_f32 v172, v172, v173
    v_mfma_f32_16x16x32_bf16 v[28:31], a[200:203], a[32:35], v[28:31]
    v_add_f32 v174, v174, v175
    v_mfma_f32_16x16x32_bf16 v[32:35], a[196:199], a[32:35], v[32:35]
    buffer_load_dwordx4 a[192:195], v2, s[12:15], s44 offen offset:3072 sc1
    v_mfma_f32_16x16x32_bf16 v[32:35], a[200:203], a[36:39], v[32:35]
    s_add_u32 s44, s44, 4096
    v_cvt_pk_bf16_f32 v170, v172, v174
    v_mfma_f32_16x16x32_bf16 v[36:39], a[196:199], a[36:39], v[36:39]
    ds_read_b128 a[100:103], v185 offset:28288
    v_mfma_f32_16x16x32_bf16 v[36:39], a[200:203], a[40:43], v[36:39]
    v_lshlrev_b32 v172, 16, v163
    v_mfma_f32_16x16x32_bf16 v[40:43], a[196:199], a[40:43], v[40:43]
    v_lshlrev_b32 v173, 16, v167
    v_mfma_f32_16x16x32_bf16 v[40:43], a[200:203], a[44:47], v[40:43]
    v_and_b32 v174, 0xffff0000, v163
    v_mfma_f32_16x16x32_bf16 v[44:47], a[196:199], a[44:47], v[44:47]
    ds_read_b128 a[104:107], v185 offset:29376
    v_mfma_f32_16x16x32_bf16 v[44:47], a[200:203], a[48:51], v[44:47]
    s_waitcnt vmcnt(24)
    v_mfma_f32_16x16x32_bf16 v[16:19], a[204:207], a[24:27], v[16:19]
    v_and_b32 v175, 0xffff0000, v167
    v_mfma_f32_16x16x32_bf16 v[16:19], a[208:211], a[28:31], v[16:19]
    buffer_load_dwordx4 a[196:199], v2, s[12:15], s44 offen offset:0 sc1
    v_mfma_f32_16x16x32_bf16 v[20:23], a[204:207], a[28:31], v[20:23]
    v_add_f32 v172, v172, v173
    v_mfma_f32_16x16x32_bf16 v[20:23], a[208:211], a[32:35], v[20:23]
    v_add_f32 v174, v174, v175
    v_mfma_f32_16x16x32_bf16 v[24:27], a[204:207], a[32:35], v[24:27]
    ds_read_b128 a[108:111], v185 offset:30464
    v_mfma_f32_16x16x32_bf16 v[24:27], a[208:211], a[36:39], v[24:27]
    v_cvt_pk_bf16_f32 v171, v172, v174
    v_mfma_f32_16x16x32_bf16 v[28:31], a[204:207], a[36:39], v[28:31]
    ds_read_b128 a[112:115], v185 offset:31552
    v_mfma_f32_16x16x32_bf16 v[28:31], a[208:211], a[40:43], v[28:31]
    ds_read_b128 a[116:119], v185 offset:32640
    v_mfma_f32_16x16x32_bf16 v[32:35], a[204:207], a[40:43], v[32:35]
    buffer_load_dwordx4 a[200:203], v2, s[12:15], s44 offen offset:1024 sc1
    v_mfma_f32_16x16x32_bf16 v[32:35], a[208:211], a[44:47], v[32:35]
    ds_write_b128 v5, v[168:171] offset:44608
    v_mfma_f32_16x16x32_bf16 v[36:39], a[204:207], a[44:47], v[36:39]
    v_xor_b32 v184, 65536, v184
    v_mfma_f32_16x16x32_bf16 v[36:39], a[208:211], a[48:51], v[36:39]
    v_xor_b32 v185, 65536, v185
    v_mfma_f32_16x16x32_bf16 v[40:43], a[204:207], a[48:51], v[40:43]
    v_xor_b32 v186, 65536, v186
    v_mfma_f32_16x16x32_bf16 v[40:43], a[208:211], a[52:55], v[40:43]
    v_xor_b32 v6, 65536, v6
    v_mfma_f32_16x16x32_bf16 v[44:47], a[204:207], a[52:55], v[44:47]
    v_xor_b32 v187, 65536, v187
    v_mfma_f32_16x16x32_bf16 v[44:47], a[208:211], a[56:59], v[44:47]
    s_waitcnt vmcnt(16) lgkmcnt(0)
    s_barrier
    v_mfma_f32_16x16x32_bf16 v[48:51], a[212:215], a[60:63], v[48:51]
    ds_read_b32 v176, v187 offset:8704
L_pg2:
    s_cbranch_execz L_tret
    v_mfma_f32_16x16x32_bf16 v[48:51], a[216:219], a[64:67], v[48:51]
    buffer_load_dwordx4 a[204:207], v2, s[12:15], s44 offen offset:2048 sc1
    v_mfma_f32_16x16x32_bf16 v[52:55], a[212:215], a[64:67], v[52:55]
    ds_read_b32 v177, v187 offset:1088
    v_mfma_f32_16x16x32_bf16 v[52:55], a[216:219], a[68:71], v[52:55]
    v_mfma_f32_16x16x32_bf16 v[56:59], a[212:215], a[68:71], v[56:59]
    ds_read_b128 a[120:123], v3 offset:43520
    v_mfma_f32_16x16x32_bf16 v[56:59], a[216:219], a[72:75], v[56:59]
    ds_read_b128 a[124:127], v3 offset:44608
    v_mfma_f32_16x16x32_bf16 v[60:63], a[212:215], a[72:75], v[60:63]
    ds_read_b128 a[128:131], v3 offset:45696
    v_mfma_f32_16x16x32_bf16 v[60:63], a[216:219], a[76:79], v[60:63]
    v_mfma_f32_16x16x32_bf16 v[64:67], a[212:215], a[76:79], v[64:67]
    ds_read_b128 a[132:135], v3 offset:46784
    v_mfma_f32_16x16x32_bf16 v[64:67], a[216:219], a[80:83], v[64:67]
    buffer_load_dwordx4 a[208:211], v2, s[12:15], s44 offen offset:3072 sc1
    v_mfma_f32_16x16x32_bf16 v[68:71], a[212:215], a[80:83], v[68:71]
    s_add_u32 s44, s44, 4096
    v_mfma_f32_16x16x32_bf16 v[68:71], a[216:219], a[84:87], v[68:71]
    s_waitcnt lgkmcnt(4)
    v_mfma_f32_16x16x32_bf16 v[72:75], a[212:215], a[84:87], v[72:75]
    s_add_u32 m0, s47, 25600
    v_mfma_f32_16x16x32_bf16 v[72:75], a[216:219], a[88:91], v[72:75]
    buffer_load_dwordx4 v10, s[4:7], s60 offen lds
    v_mfma_f32_16x16x32_bf16 v[76:79], a[212:215], a[88:91], v[76:79]
    v_lshlrev_b32 v180, 16, v176
    v_mfma_f32_16x16x32_bf16 v[76:79], a[216:219], a[92:95], v[76:79]
    s_waitcnt vmcnt(23)
    v_mfma_f32_16x16x32_bf16 v[48:51], a[220:223], a[68:71], v[48:51]
    v_mfma_f32_16x16x32_bf16 v[48:51], a[224:227], a[72:75], v[48:51]
    buffer_load_dwordx4 a[212:215], v2, s[12:15], s44 offen offset:0 sc1
    v_mfma_f32_16x16x32_bf16 v[52:55], a[220:223], a[72:75], v[52:55]
    ds_read_b128 a[136:139], v3 offset:47872
    v_mfma_f32_16x16x32_bf16 v[52:55], a[224:227], a[76:79], v[52:55]
    v_lshlrev_b32 v181, 16, v177
    v_mfma_f32_16x16x32_bf16 v[56:59], a[220:223], a[76:79], v[56:59]
    ds_read_b128 a[140:143], v3 offset:48960
    v_mfma_f32_16x16x32_bf16 v[56:59], a[224:227], a[80:83], v[56:59]
    v_mfma_f32_16x16x32_bf16 v[60:63], a[220:223], a[80:83], v[60:63]
    v_and_b32 v182, 0xffff0000, v176
    v_mfma_f32_16x16x32_bf16 v[60:63], a[224:227], a[84:87], v[60:63]
    ds_read_b128 a[144:147], v3 offset:50048
    v_mfma_f32_16x16x32_bf16 v[64:67], a[220:223], a[84:87], v[64:67]
    buffer_load_dwordx4 a[216:219], v2, s[12:15], s44 offen offset:1024 sc1
    v_mfma_f32_16x16x32_bf16 v[64:67], a[224:227], a[88:91], v[64:67]
    v_and_b32 v183, 0xffff0000, v177
    v_mfma_f32_16x16x32_bf16 v[68:71], a[220:223], a[88:91], v[68:71]
    ds_read_b128 a[148:151], v3 offset:51136
    v_mfma_f32_16x16x32_bf16 v[68:71], a[224:227], a[92:95], v[68:71]
    v_mfma_f32_16x16x32_bf16 v[72:75], a[220:223], a[92:95], v[72:75]
    s_add_u32 m0, s47, 29696
    v_mfma_f32_16x16x32_bf16 v[72:75], a[224:227], a[96:99], v[72:75]
    buffer_load_dwordx4 v11, s[4:7], s60 offen lds
    v_mfma_f32_16x16x32_bf16 v[76:79], a[220:223], a[96:99], v[76:79]
    v_add_f32 v180, v180, v181
    v_mfma_f32_16x16x32_bf16 v[76:79], a[224:227], a[100:103], v[76:79]
    s_waitcnt vmcnt(24)
    v_mfma_f32_16x16x32_bf16 v[48:51], a[228:231], a[76:79], v[48:51]
    ds_read_b128 a[152:155], v4 offset:43520
    v_mfma_f32_16x16x32_bf16 v[48:51], a[232:235], a[80:83], v[48:51]
    buffer_load_dwordx4 a[220:223], v2, s[12:15], s44 offen offset:2048 sc1
    v_mfma_f32_16x16x32_bf16 v[52:55], a[228:231], a[80:83], v[52:55]
    v_add_f32 v182, v182, v183
    v_mfma_f32_16x16x32_bf16 v[52:55], a[232:235], a[84:87], v[52:55]
    v_mfma_f32_16x16x32_bf16 v[56:59], a[228:231], a[84:87], v[56:59]
    ds_read_b128 a[156:159], v4 offset:44608
    v_mfma_f32_16x16x32_bf16 v[56:59], a[232:235], a[88:91], v[56:59]
    v_cvt_pk_bf16_f32 v178, v180, v182
    v_mfma_f32_16x16x32_bf16 v[60:63], a[228:231], a[88:91], v[60:63]
    ds_read_b128 a[160:163], v4 offset:45696
    v_mfma_f32_16x16x32_bf16 v[60:63], a[232:235], a[92:95], v[60:63]
    v_mfma_f32_16x16x32_bf16 v[64:67], a[228:231], a[92:95], v[64:67]
    buffer_load_dwordx4 a[224:227], v2, s[12:15], s44 offen offset:3072 sc1
    v_mfma_f32_16x16x32_bf16 v[64:67], a[232:235], a[96:99], v[64:67]
    s_add_u32 s44, s44, 4096
    v_mfma_f32_16x16x32_bf16 v[68:71], a[228:231], a[96:99], v[68:71]
    ds_read_b128 a[164:167], v4 offset:46784
    v_mfma_f32_16x16x32_bf16 v[68:71], a[232:235], a[100:103], v[68:71]
    ds_read_b128 a[168:171], v4 offset:47872
    v_mfma_f32_16x16x32_bf16 v[72:75], a[228:231], a[100:103], v[72:75]
    ds_read_b128 a[172:175], v4 offset:48960
    v_mfma_f32_16x16x32_bf16 v[72:75], a[232:235], a[104:107], v[72:75]
    v_mfma_f32_16x16x32_bf16 v[76:79], a[228:231], a[104:107], v[76:79]
    ds_read_b128 a[176:179], v4 offset:50048
    v_mfma_f32_16x16x32_bf16 v[76:79], a[232:235], a[108:111], v[76:79]
    s_waitcnt vmcnt(25)
    v_mfma_f32_16x16x32_bf16 v[48:51], a[236:239], a[84:87], v[48:51]
    ds_write_b32 v7, v178 offset:34816
    v_mfma_f32_16x16x32_bf16 v[52:55], a[236:239], a[88:91], v[52:55]
    buffer_load_dwordx4 a[228:231], v2, s[12:15], s44 offen offset:0 sc1
    v_mfma_f32_16x16x32_bf16 v[56:59], a[236:239], a[92:95], v[56:59]
    v_mfma_f32_16x16x32_bf16 v[60:63], a[236:239], a[96:99], v[60:63]
    v_mfma_f32_16x16x32_bf16 v[64:67], a[236:239], a[100:103], v[64:67]
    v_mfma_f32_16x16x32_bf16 v[68:71], a[236:239], a[104:107], v[68:71]
    buffer_load_dwordx4 a[232:235], v2, s[12:15], s44 offen offset:1024 sc1
    v_mfma_f32_16x16x32_bf16 v[72:75], a[236:239], a[108:111], v[72:75]
    v_mfma_f32_16x16x32_bf16 v[76:79], a[236:239], a[112:115], v[76:79]
    s_cmp_eq_u32 s46, 1
    s_cbranch_scc1 L_last
    s_waitcnt vmcnt(24) lgkmcnt(0)
    v_mfma_f32_16x16x32_bf16 v[80:83], v[112:115], a[120:123], v[80:83]
    ds_read_b128 v[160:163], v186 offset:8704
    v_mfma_f32_16x16x32_bf16 v[80:83], v[116:119], a[124:127], v[80:83]
    buffer_load_dwordx4 a[236:239], v2, s[12:15], s44 offen offset:2048 sc1
    v_mfma_f32_16x16x32_bf16 v[84:87], v[112:115], a[124:127], v[84:87]
    ds_read_b128 v[164:167], v186 offset:1088
    v_mfma_f32_16x16x32_bf16 v[84:87], v[116:119], a[128:131], v[84:87]
    ds_read_b128 a[0:3], v184 offset:0
    v_mfma_f32_16x16x32_bf16 v[88:91], v[112:115], a[128:131], v[88:91]
    ds_read_b128 a[4:7], v184 offset:1088
    v_mfma_f32_16x16x32_bf16 v[88:91], v[116:119], a[132:135], v[88:91]
    ds_read_b128 a[8:11], v184 offset:2176
    v_mfma_f32_16x16x32_bf16 v[92:95], v[112:115], a[132:135], v[92:95]
    ds_read_b128 a[12:15], v184 offset:3264
    v_mfma_f32_16x16x32_bf16 v[92:95], v[116:119], a[136:139], v[92:95]
    s_waitcnt lgkmcnt(4)
    v_mfma_f32_16x16x32_bf16 v[96:99], v[112:115], a[136:139], v[96:99]
    v_lshlrev_b32 v172, 16, v160
    v_mfma_f32_16x16x32_bf16 v[96:99], v[116:119], a[140:143], v[96:99]
    buffer_load_dwordx4 a[240:243], v2, s[12:15], s44 offen offset:3072 sc1
    v_mfma_f32_16x16x32_bf16 v[100:103], v[112:115], a[140:143], v[100:103]
    s_add_u32 s44, s44, 4096
    v_lshlrev_b32 v173, 16, v164
    v_mfma_f32_16x16x32_bf16 v[100:103], v[116:119], a[144:147], v[100:103]
    v_and_b32 v174, 0xffff0000, v160
    v_mfma_f32_16x16x32_bf16 v[104:107], v[112:115], a[144:147], v[104:107]
    s_add_u32 m0, s58, 17408
    ds_read_b128 a[16:19], v184 offset:4352
    v_mfma_f32_16x16x32_bf16 v[104:107], v[116:119], a[148:151], v[104:107]
    buffer_load_dword v12, s[4:7], s60 offen lds
    v_mfma_f32_16x16x32_bf16 v[108:111], v[112:115], a[148:151], v[108:111]
    v_and_b32 v175, 0xffff0000, v164
    v_mfma_f32_16x16x32_bf16 v[108:111], v[116:119], a[152:155], v[108:111]
    s_waitcnt vmcnt(25)
    v_add_f32 v172, v172, v173
    v_mfma_f32_16x16x32_bf16 v[80:83], v[120:123], a[128:131], v[80:83]
    v_add_f32 v174, v174, v175
    v_mfma_f32_16x16x32_bf16 v[80:83], v[124:127], a[132:135], v[80:83]
    buffer_load_dwordx4 v[112:115], v2, s[12:15], s44 offen offset:0 sc1
    v_mfma_f32_16x16x32_bf16 v[84:87], v[120:123], a[132:135], v[84:87]
    ds_read_b128 a[20:23], v184 offset:5440
    v_mfma_f32_16x16x32_bf16 v[84:87], v[124:127], a[136:139], v[84:87]
    v_cvt_pk_bf16_f32 v168, v172, v174
    v_mfma_f32_16x16x32_bf16 v[88:91], v[120:123], a[136:139], v[88:91]
    v_lshlrev_b32 v172, 16, v161
    v_mfma_f32_16x16x32_bf16 v[88:91], v[124:127], a[140:143], v[88:91]
    v_lshlrev_b32 v173, 16, v165
    v_mfma_f32_16x16x32_bf16 v[92:95], v[120:123], a[140:143], v[92:95]
    ds_read_b128 a[24:27], v184 offset:6528
    v_mfma_f32_16x16x32_bf16 v[92:95], v[124:127], a[144:147], v[92:95]
    v_and_b32 v174, 0xffff0000, v161
    v_mfma_f32_16x16x32_bf16 v[96:99], v[120:123], a[144:147], v[96:99]
    buffer_load_dwordx4 v[116:119], v2, s[12:15], s44 offen offset:1024 sc1
    v_mfma_f32_16x16x32_bf16 v[96:99], v[124:127], a[148:151], v[96:99]
    v_and_b32 v175, 0xffff0000, v165
    v_mfma_f32_16x16x32_bf16 v[100:103], v[120:123], a[148:151], v[100:103]
    v_add_f32 v172, v172, v173
    v_mfma_f32_16x16x32_bf16 v[100:103], v[124:127], a[152:155], v[100:103]
    ds_read_b128 a[28:31], v184 offset:7616
    v_mfma_f32_16x16x32_bf16 v[104:107], v[120:123], a[152:155], v[104:107]
    v_add_f32 v174, v174, v175
    v_mfma_f32_16x16x32_bf16 v[104:107], v[124:127], a[156:159], v[104:107]
    v_cvt_pk_bf16_f32 v169, v172, v174
    v_mfma_f32_16x16x32_bf16 v[108:111], v[120:123], a[156:159], v[108:111]
    v_lshlrev_b32 v172, 16, v162
    v_mfma_f32_16x16x32_bf16 v[108:111], v[124:127], a[160:163], v[108:111]
    s_waitcnt vmcnt(25)
    ds_read_b128 a[32:35], v185 offset:0
    v_mfma_f32_16x16x32_bf16 v[80:83], v[128:131], a[136:139], v[80:83]
    v_lshlrev_b32 v173, 16, v166
    v_mfma_f32_16x16x32_bf16 v[80:83], v[132:135], a[140:143], v[80:83]
    buffer_load_dwordx4 v[120:123], v2, s[12:15], s44 offen offset:2048 sc1
    v_mfma_f32_16x16x32_bf16 v[84:87], v[128:131], a[140:143], v[84:87]
    v_and_b32 v174, 0xffff0000, v162
    v_mfma_f32_16x16x32_bf16 v[84:87], v[132:135], a[144:147], v[84:87]
    v_and_b32 v175, 0xffff0000, v166
    v_mfma_f32_16x16x32_bf16 v[88:91], v[128:131], a[144:147], v[88:91]
    ds_read_b128 a[36:39], v185 offset:1088
    v_mfma_f32_16x16x32_bf16 v[88:91], v[132:135], a[148:151], v[88:91]
    v_add_f32 v172, v172, v173
    v_mfma_f32_16x16x32_bf16 v[92:95], v[128:131], a[148:151], v[92:95]
    v_add_f32 v174, v174, v175
    v_mfma_f32_16x16x32_bf16 v[92:95], v[132:135], a[152:155], v[92:95]
    v_cvt_pk_bf16_f32 v170, v172, v174
    v_mfma_f32_16x16x32_bf16 v[96:99], v[128:131], a[152:155], v[96:99]
    buffer_load_dwordx4 v[124:127], v2, s[12:15], s44 offen offset:3072 sc1
    v_mfma_f32_16x16x32_bf16 v[96:99], v[132:135], a[156:159], v[96:99]
    s_add_u32 s44, s44, 4096
    v_mfma_f32_16x16x32_bf16 v[100:103], v[128:131], a[156:159], v[100:103]
    ds_read_b128 a[40:43], v185 offset:2176
    v_mfma_f32_16x16x32_bf16 v[100:103], v[132:135], a[160:163], v[100:103]
    v_lshlrev_b32 v172, 16, v163
    v_mfma_f32_16x16x32_bf16 v[104:107], v[128:131], a[160:163], v[104:107]
    v_lshlrev_b32 v173, 16, v167
    v_mfma_f32_16x16x32_bf16 v[104:107], v[132:135], a[164:167], v[104:107]
    v_and_b32 v174, 0xffff0000, v163
    v_mfma_f32_16x16x32_bf16 v[108:111], v[128:131], a[164:167], v[108:111]
    ds_read_b128 a[44:47], v185 offset:3264
    v_mfma_f32_16x16x32_bf16 v[108:111], v[132:135], a[168:171], v[108:111]
    s_waitcnt vmcnt(25)
    v_mfma_f32_16x16x32_bf16 v[80:83], v[136:139], a[144:147], v[80:83]
    v_and_b32 v175, 0xffff0000, v167
    v_mfma_f32_16x16x32_bf16 v[80:83], v[140:143], a[148:151], v[80:83]
    buffer_load_dwordx4 v[128:131], v2, s[12:15], s44 offen offset:0 sc1
    v_mfma_f32_16x16x32_bf16 v[84:87], v[136:139], a[148:151], v[84:87]
    v_add_f32 v172, v172, v173
    v_mfma_f32_16x16x32_bf16 v[84:87], v[140:143], a[152:155], v[84:87]
    v_add_f32 v174, v174, v175
    v_mfma_f32_16x16x32_bf16 v[88:91], v[136:139], a[152:155], v[88:91]
    ds_read_b128 a[48:51], v185 offset:4352
    v_mfma_f32_16x16x32_bf16 v[88:91], v[140:143], a[156:159], v[88:91]
    v_cvt_pk_bf16_f32 v171, v172, v174
    v_mfma_f32_16x16x32_bf16 v[92:95], v[136:139], a[156:159], v[92:95]
    ds_read_b128 a[52:55], v185 offset:5440
    v_mfma_f32_16x16x32_bf16 v[92:95], v[140:143], a[160:163], v[92:95]
    ds_read_b128 a[56:59], v185 offset:6528
    v_mfma_f32_16x16x32_bf16 v[96:99], v[136:139], a[160:163], v[96:99]
    buffer_load_dwordx4 v[132:135], v2, s[12:15], s44 offen offset:1024 sc1
    v_mfma_f32_16x16x32_bf16 v[96:99], v[140:143], a[164:167], v[96:99]
    ds_write_b128 v5, v[168:171] offset:34816
    v_mfma_f32_16x16x32_bf16 v[100:103], v[136:139], a[164:167], v[100:103]
    s_xor_b32 s47, s47, 65536
    s_xor_b32 s58, s58, 65536
    v_mfma_f32_16x16x32_bf16 v[100:103], v[140:143], a[168:171], v[100:103]
    s_add_u32 s45, s45, 64
    s_and_b32 s45, s45, 0x1ff
    v_mfma_f32_16x16x32_bf16 v[104:107], v[136:139], a[168:171], v[104:107]
    s_add_u32 s60, s45, 512
    s_sub_u32 s46, s46, 1
    v_mfma_f32_16x16x32_bf16 v[104:107], v[140:143], a[172:175], v[104:107]
    v_mfma_f32_16x16x32_bf16 v[108:111], v[136:139], a[172:175], v[108:111]
    v_mfma_f32_16x16x32_bf16 v[108:111], v[140:143], a[176:179], v[108:111]
    s_branch L_loop
L_last:
    s_waitcnt vmcnt(18) lgkmcnt(0)
    v_mfma_f32_16x16x32_bf16 v[80:83], v[112:115], a[120:123], v[80:83]
    v_add_f32 v188, v20, v48
    v_add_f32 v189, v21, v49
    v_mfma_f32_16x16x32_bf16 v[80:83], v[116:119], a[124:127], v[80:83]
    v_add_f32 v190, v22, v50
    v_add_f32 v191, v23, v51
    v_mfma_f32_16x16x32_bf16 v[84:87], v[112:115], a[124:127], v[84:87]
    v_add_f32 v48, v16, v48
    v_add_f32 v49, v17, v49
    v_mfma_f32_16x16x32_bf16 v[84:87], v[116:119], a[128:131], v[84:87]
    v_add_f32 v50, v18, v50
    v_add_f32 v51, v19, v51
    v_mfma_f32_16x16x32_bf16 v[88:91], v[112:115], a[128:131], v[88:91]
    v_mul_f32 v236, v48, v48
    v_mul_f32 v237, v49, v49
    v_mfma_f32_16x16x32_bf16 v[88:91], v[116:119], a[132:135], v[88:91]
    v_mul_f32 v238, v50, v50
    v_mul_f32 v239, v51, v51
    v_mfma_f32_16x16x32_bf16 v[92:95], v[112:115], a[132:135], v[92:95]
    v_add_f32 v192, v24, v52
    v_add_f32 v193, v25, v53
    v_mfma_f32_16x16x32_bf16 v[92:95], v[116:119], a[136:139], v[92:95]
    v_add_f32 v194, v26, v54
    v_add_f32 v195, v27, v55
    v_mfma_f32_16x16x32_bf16 v[96:99], v[112:115], a[136:139], v[96:99]
    v_add_f32 v52, v20, v52
    v_add_f32 v53, v21, v53
    v_mfma_f32_16x16x32_bf16 v[96:99], v[116:119], a[140:143], v[96:99]
    v_add_f32 v54, v22, v54
    v_add_f32 v55, v23, v55
    v_mfma_f32_16x16x32_bf16 v[100:103], v[112:115], a[140:143], v[100:103]
    v_add_f32 v232, v48, v52
    v_fmac_f32 v236, v52, v52
    v_mfma_f32_16x16x32_bf16 v[100:103], v[116:119], a[144:147], v[100:103]
    v_add_f32 v233, v49, v53
    v_fmac_f32 v237, v53, v53
    v_mfma_f32_16x16x32_bf16 v[104:107], v[112:115], a[144:147], v[104:107]
    v_add_f32 v234, v50, v54
    v_fmac_f32 v238, v54, v54
    v_mfma_f32_16x16x32_bf16 v[104:107], v[116:119], a[148:151], v[104:107]
    v_add_f32 v235, v51, v55
    v_fmac_f32 v239, v55, v55
    v_mfma_f32_16x16x32_bf16 v[108:111], v[112:115], a[148:151], v[108:111]
    v_add_f32 v196, v28, v56
    v_add_f32 v197, v29, v57
    v_mfma_f32_16x16x32_bf16 v[108:111], v[116:119], a[152:155], v[108:111]
    v_add_f32 v198, v30, v58
    v_add_f32 v199, v31, v59
    v_mfma_f32_16x16x32_bf16 v[80:83], v[120:123], a[128:131], v[80:83]
    v_add_f32 v56, v24, v56
    v_add_f32 v57, v25, v57
    v_mfma_f32_16x16x32_bf16 v[80:83], v[124:127], a[132:135], v[80:83]
    v_add_f32 v58, v26, v58
    v_add_f32 v59, v27, v59
    v_mfma_f32_16x16x32_bf16 v[84:87], v[120:123], a[132:135], v[84:87]
    v_add_f32 v232, v232, v56
    v_fmac_f32 v236, v56, v56
    v_mfma_f32_16x16x32_bf16 v[84:87], v[124:127], a[136:139], v[84:87]
    v_add_f32 v233, v233, v57
    v_fmac_f32 v237, v57, v57
    v_mfma_f32_16x16x32_bf16 v[88:91], v[120:123], a[136:139], v[88:91]
    v_add_f32 v234, v234, v58
    v_fmac_f32 v238, v58, v58
    v_mfma_f32_16x16x32_bf16 v[88:91], v[124:127], a[140:143], v[88:91]
    v_add_f32 v235, v235, v59
    v_fmac_f32 v239, v59, v59
    v_mfma_f32_16x16x32_bf16 v[92:95], v[120:123], a[140:143], v[92:95]
    v_add_f32 v200, v32, v60
    v_add_f32 v201, v33, v61
    v_mfma_f32_16x16x32_bf16 v[92:95], v[124:127], a[144:147], v[92:95]
    v_add_f32 v202, v34, v62
    v_add_f32 v203, v35, v63
    v_mfma_f32_16x16x32_bf16 v[96:99], v[120:123], a[144:147], v[96:99]
    v_add_f32 v60, v28, v60
    v_add_f32 v61, v29, v61
    v_mfma_f32_16x16x32_bf16 v[96:99], v[124:127], a[148:151], v[96:99]
    v_add_f32 v62, v30, v62
    v_add_f32 v63, v31, v63
    v_mfma_f32_16x16x32_bf16 v[100:103], v[120:123], a[148:151], v[100:103]
    v_add_f32 v232, v232, v60
    v_fmac_f32 v236, v60, v60
    v_mfma_f32_16x16x32_bf16 v[100:103], v[124:127], a[152:155], v[100:103]
    v_add_f32 v233, v233, v61
    v_fmac_f32 v237, v61, v61
    v_mfma_f32_16x16x32_bf16 v[104:107], v[120:123], a[152:155], v[104:107]
    v_add_f32 v234, v234, v62
    v_fmac_f32 v238, v62, v62
    v_mfma_f32_16x16x32_bf16 v[104:107], v[124:127], a[156:159], v[104:107]
    v_add_f32 v235, v235, v63
    v_fmac_f32 v239, v63, v63
    v_mfma_f32_16x16x32_bf16 v[108:111], v[120:123], a[156:159], v[108:111]
    v_add_f32 v204, v36, v64
    v_add_f32 v205, v37, v65
    v_mfma_f32_16x16x32_bf16 v[108:111], v[124:127], a[160:163], v[108:111]
    v_add_f32 v206, v38, v66
    v_add_f32 v207, v39, v67
    v_mfma_f32_16x16x32_bf16 v[80:83], v[128:131], a[136:139], v[80:83]
    v_add_f32 v64, v32, v64
    v_add_f32 v65, v33, v65
    v_mfma_f32_16x16x32_bf16 v[80:83], v[132:135], a[140:143], v[80:83]
    v_add_f32 v66, v34, v66
    v_add_f32 v67, v35, v67
    v_mfma_f32_16x16x32_bf16 v[84:87], v[128:131], a[140:143], v[84:87]
    v_add_f32 v232, v232, v64
    v_fmac_f32 v236, v64, v64
    v_mfma_f32_16x16x32_bf16 v[84:87], v[132:135], a[144:147], v[84:87]
    v_add_f32 v233, v233, v65
    v_fmac_f32 v237, v65, v65
    v_mfma_f32_16x16x32_bf16 v[88:91], v[128:131], a[144:147], v[88:91]
    v_add_f32 v234, v234, v66
    v_fmac_f32 v238, v66, v66
    v_mfma_f32_16x16x32_bf16 v[88:91], v[132:135], a[148:151], v[88:91]
    v_add_f32 v235, v235, v67
    v_fmac_f32 v239, v67, v67
    v_mfma_f32_16x16x32_bf16 v[92:95], v[128:131], a[148:151], v[92:95]
    v_add_f32 v208, v40, v68
    v_add_f32 v209, v41, v69
    v_mfma_f32_16x16x32_bf16 v[92:95], v[132:135], a[152:155], v[92:95]
    v_add_f32 v210, v42, v70
    v_add_f32 v211, v43, v71
    v_mfma_f32_16x16x32_bf16 v[96:99], v[128:131], a[152:155], v[96:99]
    v_add_f32 v68, v36, v68
    v_add_f32 v69, v37, v69
    v_mfma_f32_16x16x32_bf16 v[96:99], v[132:135], a[156:159], v[96:99]
    v_add_f32 v70, v38, v70
    v_add_f32 v71, v39, v71
    v_mfma_f32_16x16x32_bf16 v[100:103], v[128:131], a[156:159], v[100:103]
    v_add_f32 v232, v232, v68
    v_fmac_f32 v236, v68, v68
    v_mfma_f32_16x16x32_bf16 v[100:103], v[132:135], a[160:163], v[100:103]
    v_add_f32 v233, v233, v69
    v_fmac_f32 v237, v69, v69
    v_mfma_f32_16x16x32_bf16 v[104:107], v[128:131], a[160:163], v[104:107]
    v_add_f32 v234, v234, v70
    v_fmac_f32 v238, v70, v70
    v_mfma_f32_16x16x32_bf16 v[104:107], v[132:135], a[164:167], v[104:107]
    v_add_f32 v235, v235, v71
    v_fmac_f32 v239, v71, v71
    v_mfma_f32_16x16x32_bf16 v[108:111], v[128:131], a[164:167], v[108:111]
    v_add_f32 v212, v44, v72
    v_add_f32 v213, v45, v73
    v_mfma_f32_16x16x32_bf16 v[108:111], v[132:135], a[168:171], v[108:111]
    v_add_f32 v214, v46, v74
    v_add_f32 v215, v47, v75
    v_mfma_f32_16x16x32_bf16 v[80:83], v[136:139], a[144:147], v[80:83]
    v_add_f32 v72, v40, v72
    v_add_f32 v73, v41, v73
    v_mfma_f32_16x16x32_bf16 v[80:83], v[140:143], a[148:151], v[80:83]
    v_add_f32 v74, v42, v74
    v_add_f32 v75, v43, v75
    v_mfma_f32_16x16x32_bf16 v[84:87], v[136:139], a[148:151], v[84:87]
    v_add_f32 v232, v232, v72
    v_fmac_f32 v236, v72, v72
    v_mfma_f32_16x16x32_bf16 v[84:87], v[140:143], a[152:155], v[84:87]
    v_add_f32 v233, v233, v73
    v_fmac_f32 v237, v73, v73
    v_mfma_f32_16x16x32_bf16 v[88:91], v[136:139], a[152:155], v[88:91]
    v_add_f32 v234, v234, v74
    v_fmac_f32 v238, v74, v74
    v_mfma_f32_16x16x32_bf16 v[88:91], v[140:143], a[156:159], v[88:91]
    v_add_f32 v235, v235, v75
    v_fmac_f32 v239, v75, v75
    v_mfma_f32_16x16x32_bf16 v[92:95], v[136:139], a[156:159], v[92:95]
    v_add_f32_dpp v216, v16, v76 row_shl:1 row_mask:0xf bank_mask:0xf bound_ctrl:0
    v_add_f32_dpp v217, v17, v77 row_shl:1 row_mask:0xf bank_mask:0xf bound_ctrl:0
    v_mfma_f32_16x16x32_bf16 v[92:95], v[140:143], a[160:163], v[92:95]
    v_add_f32_dpp v218, v18, v78 row_shl:1 row_mask:0xf bank_mask:0xf bound_ctrl:0
    v_add_f32_dpp v219, v19, v79 row_shl:1 row_mask:0xf bank_mask:0xf bound_ctrl:0
    v_mfma_f32_16x16x32_bf16 v[96:99], v[136:139], a[160:163], v[96:99]
    v_add_f32 v76, v44, v76
    v_add_f32 v77, v45, v77
    v_mfma_f32_16x16x32_bf16 v[96:99], v[140:143], a[164:167], v[96:99]
    v_add_f32 v78, v46, v78
    v_add_f32 v79, v47, v79
    v_mfma_f32_16x16x32_bf16 v[100:103], v[136:139], a[164:167], v[100:103]
    v_add_f32 v232, v232, v76
    v_fmac_f32 v236, v76, v76
    v_mfma_f32_16x16x32_bf16 v[100:103], v[140:143], a[168:171], v[100:103]
    v_add_f32 v233, v233, v77
    v_fmac_f32 v237, v77, v77
    v_mfma_f32_16x16x32_bf16 v[104:107], v[136:139], a[168:171], v[104:107]
    v_add_f32 v234, v234, v78
    v_fmac_f32 v238, v78, v78
    v_mfma_f32_16x16x32_bf16 v[104:107], v[140:143], a[172:175], v[104:107]
    v_add_f32 v235, v235, v79
    v_fmac_f32 v239, v79, v79
    v_mfma_f32_16x16x32_bf16 v[108:111], v[136:139], a[172:175], v[108:111]
    v_mfma_f32_16x16x32_bf16 v[108:111], v[140:143], a[176:179], v[108:111]
    v_pk_add_f32 v[80:81], v[80:81], v[188:189] neg_lo:[0,1] neg_hi:[0,1]
    v_pk_add_f32 v[82:83], v[82:83], v[190:191] neg_lo:[0,1] neg_hi:[0,1]
    v_pk_add_f32 v[84:85], v[84:85], v[192:193] neg_lo:[0,1] neg_hi:[0,1]
    v_pk_add_f32 v[86:87], v[86:87], v[194:195] neg_lo:[0,1] neg_hi:[0,1]
    v_pk_add_f32 v[232:233], v[232:233], v[80:81]
    v_pk_fma_f32 v[236:237], v[80:81], v[80:81], v[236:237]
    v_pk_add_f32 v[234:235], v[234:235], v[82:83]
    v_pk_fma_f32 v[238:239], v[82:83], v[82:83], v[238:239]
    v_pk_add_f32 v[88:89], v[88:89], v[196:197] neg_lo:[0,1] neg_hi:[0,1]
    v_pk_add_f32 v[90:91], v[90:91], v[198:199] neg_lo:[0,1] neg_hi:[0,1]
    v_pk_add_f32 v[232:233], v[232:233], v[84:85]
    v_pk_fma_f32 v[236:237], v[84:85], v[84:85], v[236:237]
    v_pk_add_f32 v[234:235], v[234:235], v[86:87]
    v_pk_fma_f32 v[238:239], v[86:87], v[86:87], v[238:239]
    v_pk_add_f32 v[92:93], v[92:93], v[200:201] neg_lo:[0,1] neg_hi:[0,1]
    v_pk_add_f32 v[94:95], v[94:95], v[202:203] neg_lo:[0,1] neg_hi:[0,1]
    v_pk_add_f32 v[232:233], v[232:233], v[88:89]
    v_pk_fma_f32 v[236:237], v[88:89], v[88:89], v[236:237]
    v_pk_add_f32 v[234:235], v[234:235], v[90:91]
    v_pk_fma_f32 v[238:239], v[90:91], v[90:91], v[238:239]
    v_pk_add_f32 v[96:97], v[96:97], v[204:205] neg_lo:[0,1] neg_hi:[0,1]
    v_pk_add_f32 v[98:99], v[98:99], v[206:207] neg_lo:[0,1] neg_hi:[0,1]
    v_pk_add_f32 v[232:233], v[232:233], v[92:93]
    v_pk_fma_f32 v[236:237], v[92:93], v[92:93], v[236:237]
    v_pk_add_f32 v[234:235], v[234:235], v[94:95]
    v_pk_fma_f32 v[238:239], v[94:95], v[94:95], v[238:239]
    v_pk_add_f32 v[100:101], v[100:101], v[208:209] neg_lo:[0,1] neg_hi:[0,1]
    v_pk_add_f32 v[102:103], v[102:103], v[210:211] neg_lo:[0,1] neg_hi:[0,1]
    v_pk_add_f32 v[232:233], v[232:233], v[96:97]
    v_pk_fma_f32 v[236:237], v[96:97], v[96:97], v[236:237]
    v_pk_add_f32 v[234:235], v[234:235], v[98:99]
    v_pk_fma_f32 v[238:239], v[98:99], v[98:99], v[238:239]
    v_pk_add_f32 v[104:105], v[104:105], v[212:213] neg_lo:[0,1] neg_hi:[0,1]
    v_pk_add_f32 v[106:107], v[106:107], v[214:215] neg_lo:[0,1] neg_hi:[0,1]
    v_pk_add_f32 v[232:233], v[232:233], v[100:101]
    v_pk_fma_f32 v[236:237], v[100:101], v[100:101], v[236:237]
    v_pk_add_f32 v[234:235], v[234:235], v[102:103]
    v_pk_fma_f32 v[238:239], v[102:103], v[102:103], v[238:239]
    v_pk_add_f32 v[108:109], v[108:109], v[216:217] neg_lo:[0,1] neg_hi:[0,1]
    v_pk_add_f32 v[110:111], v[110:111], v[218:219] neg_lo:[0,1] neg_hi:[0,1]
    v_pk_add_f32 v[232:233], v[232:233], v[104:105]
    v_pk_fma_f32 v[236:237], v[104:105], v[104:105], v[236:237]
    v_pk_add_f32 v[234:235], v[234:235], v[106:107]
    v_pk_fma_f32 v[238:239], v[106:107], v[106:107], v[238:239]
    s_mov_b64 exec, s[66:67]
    s_cmp_eq_u32 s38, 31
    v_pk_add_f32 v[232:233], v[232:233], v[108:109]
    v_pk_fma_f32 v[236:237], v[108:109], v[108:109], v[236:237]
    v_pk_add_f32 v[234:235], v[234:235], v[110:111]
    v_pk_fma_f32 v[238:239], v[110:111], v[110:111], v[238:239]
    s_mov_b64 exec, -1
    s_cbranch_scc0 L_nomask
    v_cndmask_b32 v232, 0, v232, s[64:65]
    v_cndmask_b32 v233, 0, v233, s[64:65]
    v_cndmask_b32 v234, 0, v234, s[64:65]
    v_cndmask_b32 v235, 0, v235, s[64:65]
    v_cndmask_b32 v236, 0, v236, s[64:65]
    v_cndmask_b32 v237, 0, v237, s[64:65]
    v_cndmask_b32 v238, 0, v238, s[64:65]
    v_cndmask_b32 v239, 0, v239, s[64:65]
L_nomask:
    s_nop 0
    v_add_f32_dpp v240, v232, v232 row_ror:8 row_mask:0xf bank_mask:0x3
    v_add_f32_dpp v240, v236, v236 row_ror:8 row_mask:0xf bank_mask:0xc
    v_add_f32_dpp v242, v234, v234 row_ror:8 row_mask:0xf bank_mask:0x3
    v_add_f32_dpp v242, v238, v238 row_ror:8 row_mask:0xf bank_mask:0xc
    v_add_f32_dpp v241, v233, v233 row_ror:8 row_mask:0xf bank_mask:0x3
    v_add_f32_dpp v241, v237, v237 row_ror:8 row_mask:0xf bank_mask:0xc
    v_add_f32_dpp v243, v235, v235 row_ror:8 row_mask:0xf bank_mask:0x3
    v_add_f32_dpp v243, v239, v239 row_ror:8 row_mask:0xf bank_mask:0xc
    v_add_f32_dpp v244, v240, v240 row_shl:4 row_mask:0xf bank_mask:0x5
    v_add_f32_dpp v244, v242, v242 row_shr:4 row_mask:0xf bank_mask:0xa
    v_add_f32_dpp v245, v241, v241 row_shl:4 row_mask:0xf bank_mask:0x5
    v_add_f32_dpp v245, v243, v243 row_shr:4 row_mask:0xf bank_mask:0xa
    v_add_f32_dpp v244, v244, v244 quad_perm:[2,3,0,1] row_mask:0xf bank_mask:0xf
    s_nop 0
    v_add_f32_dpp v245, v245, v245 quad_perm:[2,3,0,1] row_mask:0xf bank_mask:0xf
    s_nop 0
    v_add_f32_dpp v244, v244, v244 quad_perm:[1,0,3,2] row_mask:0xf bank_mask:0xf
    s_nop 0
    v_add_f32_dpp v245, v245, v245 quad_perm:[1,0,3,2] row_mask:0xf bank_mask:0xf
    v_cndmask_b32 v246, v244, v245, s[68:69]
    buffer_store_dwordx2 v[246:247], v248, s[32:35], s63 offen sc1
    s_mov_b32 s50, s62
    v_lshrrev_b32 v14, 4, v1
    v_lshlrev_b32 v14, 6, v14
    v_and_b32 v15, 3, v13
    v_lshl_add_u32 v14, v15, 4, v14
    v_lshrrev_b32 v15, 2, v13
    v_lshl_add_u32 v14, v15, 8, v14
    s_add_u32 s51, s50, 4096
    v_lshlrev_b32 v144, 16, v144
    v_lshlrev_b32 v145, 16, v145
    v_lshlrev_b32 v146, 16, v146
    s_mul_i32 s56, s36, 4088320
    s_add_u32 s8, s26, s56
    s_addc_u32 s9, s27, 0
    s_mov_b32 s10, 4088320
    s_mov_b32 s46, 30000
    v_mul_u32_u24 v188, 2064, v13
    v_lshrrev_b32 v15, 4, v1
    v_lshl_add_u32 v188, v15, 3, v188
    s_lshl_b32 s56, s39, 5
    s_add_u32 s56, s56, 100352
    v_add_u32 v188, s56, v188
    v_lshrrev_b32 v195, 5, v1
    s_lshl_b32 s56, s39, 2
    v_add_u32 v195, s56, v195
    v_and_b32 v196, 31, v1
    v_mul_u32_u24 v189, 2064, v195
    v_lshl_add_u32 v189, v196, 4, v189
    v_add_u32 v189, 100352, v189
    v_bfe_u32 v196, v1, 3, 2
    v_lshlrev_b32 v195, 13, v195
    v_lshl_add_u32 v195, v196, 9, v195
    v_and_b32 v196, 7, v1
    v_lshl_add_u32 v195, v196, 4, v195
    s_mul_i32 s56, s38, 130560
    s_lshl_b32 s57, s37, 7
    s_add_u32 s56, s56, s57
    v_add_u32 v190, s56, v195
    v_add_u32 v191, 4096, v190
    v_add_u32 v192, 16384, v190
    v_add_u32 v193, 20480, v190
    v_cmp_gt_u32 vcc, 248, v0
    v_mov_b32 v194, 0x40000000
    s_nop 0
    v_cndmask_b32 v194, v194, v193, vcc
    s_or_b32 s57, s38, s36
    s_cmp_eq_u32 s57, 0
    s_cbranch_scc0 L_noep
    v_mov_b32 v138, s41
    s_lshl_b32 s56, s37, 8
    s_add_u32 s56, s56, 2097152
    v_mov_b32 v139, s56
    v_cmp_eq_u32 vcc, 0, v0
    s_and_saveexec_b64 s[56:57], vcc
    buffer_store_dword v138, v139, s[32:35], 0 offen sc1
    s_mov_b64 exec, s[56:57]
L_noep:
    v_mov_b32 v140, 0xc0135761
    v_mov_b32 v141, 0xc0135761
    v_mov_b32 v142, 0xbdd2d3e8
    v_mov_b32 v143, 0xbdd2d3e8
    s_mov_b32 s56, 0x39035177
    s_mov_b32 s57, 0x3727c5ac
L_poll2:
    buffer_load_dwordx4 v[152:155], v14, s[32:35], s50 offen offset:0 sc1
    buffer_load_dwordx4 v[156:159], v14, s[32:35], s50 offen offset:1024 sc1
    buffer_load_dwordx4 v[160:163], v14, s[32:35], s50 offen offset:2048 sc1
    buffer_load_dwordx4 v[164:167], v14, s[32:35], s50 offen offset:3072 sc1
    buffer_load_dwordx4 v[168:171], v14, s[32:35], s51 offen offset:0 sc1
    buffer_load_dwordx4 v[172:175], v14, s[32:35], s51 offen offset:1024 sc1
    buffer_load_dwordx4 v[176:179], v14, s[32:35], s51 offen offset:2048 sc1
    buffer_load_dwordx4 v[180:183], v14, s[32:35], s51 offen offset:3072 sc1
    s_sub_u32 s46, s46, 1
    s_cbranch_scc1 L_poll2_done
    s_waitcnt vmcnt(7)
    v_xor_b32 v153, s41, v153
    v_xor_b32 v155, s42, v155
    v_or_b32 v138, v153, v155
    s_waitcnt vmcnt(6)
    v_xor_b32 v157, s41, v157
    v_xor_b32 v159, s42, v159
    v_or3_b32 v138, v138, v157, v159
    v_add_f32 v152, v152, v156
    v_add_f32 v154, v154, v158
    s_waitcnt vmcnt(5)
    v_xor_b32 v161, s41, v161
    v_xor_b32 v163, s42, v163
    v_or3_b32 v138, v138, v161, v163
    v_add_f32 v152, v152, v160
    v_add_f32 v154, v154, v162
    s_waitcnt vmcnt(4)
    v_xor_b32 v165, s41, v165
    v_xor_b32 v167, s42, v167
    v_or3_b32 v138, v138, v165, v167
    v_add_f32 v152, v152, v164
    v_add_f32 v154, v154, v166
    s_waitcnt vmcnt(3)
    v_xor_b32 v169, s41, v169
    v_xor_b32 v171, s42, v171
    v_or3_b32 v138, v138, v169, v171
    v_add_f32 v152, v152, v168
    v_add_f32 v154, v154, v170
    s_waitcnt vmcnt(2)
    v_xor_b32 v173, s41, v173
    v_xor_b32 v175, s42, v175
    v_or3_b32 v138, v138, v173, v175
    v_add_f32 v152, v152, v172
    v_add_f32 v154, v154, v174
    s_waitcnt vmcnt(1)
    v_xor_b32 v177, s41, v177
    v_xor_b32 v179, s42, v179
    v_or3_b32 v138, v138, v177, v179
    v_add_f32 v152, v152, v176
    v_add_f32 v154, v154, v178
    s_waitcnt vmcnt(0)
    v_xor_b32 v181, s41, v181
    v_xor_b32 v183, s42, v183
    v_or3_b32 v138, v138, v181, v183
    v_add_f32 v152, v152, v180
    v_add_f32 v154, v154, v182
    v_cmp_ne_u32 vcc, 0, v138
    s_cbranch_vccnz L_poll2
L_poll2_done:
L_seg0:
    v_add_f32_dpp v152, v152, v152 row_ror:4 row_mask:0xf bank_mask:0xf
    v_add_f32_dpp v154, v154, v154 row_ror:4 row_mask:0xf bank_mask:0xf
    s_nop 0
    v_add_f32_dpp v152, v152, v152 row_ror:8 row_mask:0xf bank_mask:0xf
    v_add_f32_dpp v154, v154, v154 row_ror:8 row_mask:0xf bank_mask:0xf
    v_mul_f32 v152, s56, v152
    v_mul_f32 v154, s56, v154
    v_fma_f32 v154, -v152, v152, v154
    v_max_f32 v154, 0, v154
    v_add_f32 v154, s57, v154
L_pg3:
    s_cbranch_execz L_tret
    v_rsq_f32 v154, v154
    v_add_f32 v152, v152, v146
    v_sub_f32 v152, v146, v152
    v_mul_f32 v154, v154, v144
    v_fma_f32 v152, v152, v154, v145
    s_nop 1
    v_mov_b32_dpp v236, v154 quad_perm:[0,0,0,0] row_mask:0xf bank_mask:0xf
    v_mov_b32_dpp v232, v152 quad_perm:[0,0,0,0] row_mask:0xf bank_mask:0xf
    v_mov_b32_dpp v237, v154 quad_perm:[1,1,1,1] row_mask:0xf bank_mask:0xf
    v_mov_b32_dpp v233, v152 quad_perm:[1,1,1,1] row_mask:0xf bank_mask:0xf
    v_mov_b32_dpp v238, v154 quad_perm:[2,2,2,2] row_mask:0xf bank_mask:0xf
    v_mov_b32_dpp v234, v152 quad_perm:[2,2,2,2] row_mask:0xf bank_mask:0xf
    v_mov_b32_dpp v239, v154 quad_perm:[3,3,3,3] row_mask:0xf bank_mask:0xf
    v_mov_b32_dpp v235, v152 quad_perm:[3,3,3,3] row_mask:0xf bank_mask:0xf
    v_pk_fma_f32 v[48:49], v[48:49], v[236:237], v[232:233]
    v_pk_fma_f32 v[50:51], v[50:51], v[238:239], v[234:235]
    v_pk_fma_f32 v[80:81], v[80:81], v[236:237], v[232:233]
    v_pk_fma_f32 v[82:83], v[82:83], v[238:239], v[234:235]
    v_pk_mul_f32 v[152:153], v[48:49], v[48:49]
    v_pk_mul_f32 v[154:155], v[50:51], v[50:51]
    v_pk_mul_f32 v[156:157], v[80:81], v[80:81]
    v_pk_mul_f32 v[158:159], v[82:83], v[82:83]
    v_pk_fma_f32 v[152:153], v[152:153], v[142:143], v[140:141]
    v_pk_fma_f32 v[154:155], v[154:155], v[142:143], v[140:141]
    v_pk_fma_f32 v[156:157], v[156:157], v[142:143], v[140:141]
    v_pk_fma_f32 v[158:159], v[158:159], v[142:143], v[140:141]
    v_pk_mul_f32 v[152:153], v[152:153], v[48:49]
    v_pk_mul_f32 v[154:155], v[154:155], v[50:51]
    v_pk_mul_f32 v[156:157], v[156:157], v[80:81]
    v_pk_mul_f32 v[158:159], v[158:159], v[82:83]
    v_exp_f32 v152, v152
    v_exp_f32 v153, v153
    v_exp_f32 v154, v154
    v_exp_f32 v155, v155
    v_exp_f32 v156, v156
    v_exp_f32 v157, v157
    v_exp_f32 v158, v158
    v_exp_f32 v159, v159
    v_pk_add_f32 v[152:153], v[152:153], 1.0 op_sel_hi:[1,0]
    v_pk_add_f32 v[154:155], v[154:155], 1.0 op_sel_hi:[1,0]
    v_pk_add_f32 v[156:157], v[156:157], 1.0 op_sel_hi:[1,0]
    v_pk_add_f32 v[158:159], v[158:159], 1.0 op_sel_hi:[1,0]
    v_rcp_f32 v152, v152
    v_rcp_f32 v153, v153
    v_rcp_f32 v154, v154
    v_rcp_f32 v155, v155
    v_rcp_f32 v156, v156
    v_rcp_f32 v157, v157
    v_rcp_f32 v158, v158
    v_rcp_f32 v159, v159
    v_pk_mul_f32 v[152:153], v[152:153], v[48:49]
    v_pk_mul_f32 v[154:155], v[154:155], v[50:51]
    v_pk_mul_f32 v[156:157], v[156:157], v[80:81]
    v_pk_mul_f32 v[158:159], v[158:159], v[82:83]
    v_cvt_pk_bf16_f32 v160, v152, v153
    v_cvt_pk_bf16_f32 v161, v154, v155
    v_cvt_pk_bf16_f32 v162, v156, v157
    v_cvt_pk_bf16_f32 v163, v158, v159
    ds_write_b64 v188, v[160:161] offset:0
    ds_write_b64 v188, v[162:163] offset:128
    v_pk_fma_f32 v[52:53], v[52:53], v[236:237], v[232:233]
    v_pk_fma_f32 v[54:55], v[54:55], v[238:239], v[234:235]
    v_pk_fma_f32 v[84:85], v[84:85], v[236:237], v[232:233]
    v_pk_fma_f32 v[86:87], v[86:87], v[238:239], v[234:235]
    v_pk_mul_f32 v[152:153], v[52:53], v[52:53]
    v_pk_mul_f32 v[154:155], v[54:55], v[54:55]
    v_pk_mul_f32 v[156:157], v[84:85], v[84:85]
    v_pk_mul_f32 v[158:159], v[86:87], v[86:87]
    v_pk_fma_f32 v[152:153], v[152:153], v[142:143], v[140:141]
    v_pk_fma_f32 v[154:155], v[154:155], v[142:143], v[140:141]
    v_pk_fma_f32 v[156:157], v[156:157], v[142:143], v[140:141]
    v_pk_fma_f32 v[158:159], v[158:159], v[142:143], v[140:141]
    v_pk_mul_f32 v[152:153], v[152:153], v[52:53]
    v_pk_mul_f32 v[154:155], v[154:155], v[54:55]
    v_pk_mul_f32 v[156:157], v[156:157], v[84:85]
    v_pk_mul_f32 v[158:159], v[158:159], v[86:87]
    v_exp_f32 v152, v152
    v_exp_f32 v153, v153
    v_exp_f32 v154, v154
    v_exp_f32 v155, v155
    v_exp_f32 v156, v156
    v_exp_f32 v157, v157
    v_exp_f32 v158, v158
    v_exp_f32 v159, v159
    v_pk_add_f32 v[152:153], v[152:153], 1.0 op_sel_hi:[1,0]
    v_pk_add_f32 v[154:155], v[154:155], 1.0 op_sel_hi:[1,0]
    v_pk_add_f32 v[156:157], v[156:157], 1.0 op_sel_hi:[1,0]
    v_pk_add_f32 v[158:159], v[158:159], 1.0 op_sel_hi:[1,0]
    v_rcp_f32 v152, v152
    v_rcp_f32 v153, v153
    v_rcp_f32 v154, v154
    v_rcp_f32 v155, v155
    v_rcp_f32 v156, v156
    v_rcp_f32 v157, v157
    v_rcp_f32 v158, v158
    v_rcp_f32 v159, v159
    v_pk_mul_f32 v[152:153], v[152:153], v[52:53]
    v_pk_mul_f32 v[154:155], v[154:155], v[54:55]
    v_pk_mul_f32 v[156:157], v[156:157], v[84:85]
    v_pk_mul_f32 v[158:159], v[158:159], v[86:87]
    v_cvt_pk_bf16_f32 v164, v152, v153
    v_cvt_pk_bf16_f32 v165, v154, v155
    v_cvt_pk_bf16_f32 v166, v156, v157
    v_cvt_pk_bf16_f32 v167, v158, v159
    ds_write_b64 v188, v[164:165] offset:256
    ds_write_b64 v188, v[166:167] offset:384
    v_pk_fma_f32 v[56:57], v[56:57], v[236:237], v[232:233]
    v_pk_fma_f32 v[58:59], v[58:59], v[238:239], v[234:235]
    v_pk_fma_f32 v[88:89], v[88:89], v[236:237], v[232:233]
    v_pk_fma_f32 v[90:91], v[90:91], v[238:239], v[234:235]
    v_pk_mul_f32 v[152:153], v[56:57], v[56:57]
    v_pk_mul_f32 v[154:155], v[58:59], v[58:59]
    v_pk_mul_f32 v[156:157], v[88:89], v[88:89]
    v_pk_mul_f32 v[158:159], v[90:91], v[90:91]
    v_pk_fma_f32 v[152:153], v[152:153], v[142:143], v[140:141]
    v_pk_fma_f32 v[154:155], v[154:155], v[142:143], v[140:141]
    v_pk_fma_f32 v[156:157], v[156:157], v[142:143], v[140:141]
    v_pk_fma_f32 v[158:159], v[158:159], v[142:143], v[140:141]
    v_pk_mul_f32 v[152:153], v[152:153], v[56:57]
    v_pk_mul_f32 v[154:155], v[154:155], v[58:59]
    v_pk_mul_f32 v[156:157], v[156:157], v[88:89]
    v_pk_mul_f32 v[158:159], v[158:159], v[90:91]
    v_exp_f32 v152, v152
    v_exp_f32 v153, v153
    v_exp_f32 v154, v154
    v_exp_f32 v155, v155
    v_exp_f32 v156, v156
    v_exp_f32 v157, v157
    v_exp_f32 v158, v158
    v_exp_f32 v159, v159
    v_pk_add_f32 v[152:153], v[152:153], 1.0 op_sel_hi:[1,0]
    v_pk_add_f32 v[154:155], v[154:155], 1.0 op_sel_hi:[1,0]
    v_pk_add_f32 v[156:157], v[156:157], 1.0 op_sel_hi:[1,0]
    v_pk_add_f32 v[158:159], v[158:159], 1.0 op_sel_hi:[1,0]
    v_rcp_f32 v152, v152
    v_rcp_f32 v153, v153
    v_rcp_f32 v154, v154
    v_rcp_f32 v155, v155
    v_rcp_f32 v156, v156
    v_rcp_f32 v157, v157
    v_rcp_f32 v158, v158
    v_rcp_f32 v159, v159
    v_pk_mul_f32 v[152:153], v[152:153], v[56:57]
    v_pk_mul_f32 v[154:155], v[154:155], v[58:59]
    v_pk_mul_f32 v[156:157], v[156:157], v[88:89]
    v_pk_mul_f32 v[158:159], v[158:159], v[90:91]
    v_cvt_pk_bf16_f32 v160, v152, v153
    v_cvt_pk_bf16_f32 v161, v154, v155
    v_cvt_pk_bf16_f32 v162, v156, v157
    v_cvt_pk_bf16_f32 v163, v158, v159
    ds_write_b64 v188, v[160:161] offset:512
    ds_write_b64 v188, v[162:163] offset:640
    v_pk_fma_f32 v[60:61], v[60:61], v[236:237], v[232:233]
    v_pk_fma_f32 v[62:63], v[62:63], v[238:239], v[234:235]
    v_pk_fma_f32 v[92:93], v[92:93], v[236:237], v[232:233]
    v_pk_fma_f32 v[94:95], v[94:95], v[238:239], v[234:235]
    v_pk_mul_f32 v[152:153], v[60:61], v[60:61]
    v_pk_mul_f32 v[154:155], v[62:63], v[62:63]
    v_pk_mul_f32 v[156:157], v[92:93], v[92:93]
    v_pk_mul_f32 v[158:159], v[94:95], v[94:95]
    v_pk_fma_f32 v[152:153], v[152:153], v[142:143], v[140:141]
    v_pk_fma_f32 v[154:155], v[154:155], v[142:143], v[140:141]
    v_pk_fma_f32 v[156:157], v[156:157], v[142:143], v[140:141]
    v_pk_fma_f32 v[158:159], v[158:159], v[142:143], v[140:141]
    v_pk_mul_f32 v[152:153], v[152:153], v[60:61]
    v_pk_mul_f32 v[154:155], v[154:155], v[62:63]
    v_pk_mul_f32 v[156:157], v[156:157], v[92:93]
    v_pk_mul_f32 v[158:159], v[158:159], v[94:95]
    v_exp_f32 v152, v152
    v_exp_f32 v153, v153
    v_exp_f32 v154, v154
    v_exp_f32 v155, v155
    v_exp_f32 v156, v156
    v_exp_f32 v157, v157
    v_exp_f32 v158, v158
    v_exp_f32 v159, v159
    v_pk_add_f32 v[152:153], v[152:153], 1.0 op_sel_hi:[1,0]
    v_pk_add_f32 v[154:155], v[154:155], 1.0 op_sel_hi:[1,0]
    v_pk_add_f32 v[156:157], v[156:157], 1.0 op_sel_hi:[1,0]
    v_pk_add_f32 v[158:159], v[158:159], 1.0 op_sel_hi:[1,0]
    v_rcp_f32 v152, v152
    v_rcp_f32 v153, v153
    v_rcp_f32 v154, v154
    v_rcp_f32 v155, v155
    v_rcp_f32 v156, v156
    v_rcp_f32 v157, v157
    v_rcp_f32 v158, v158
    v_rcp_f32 v159, v159
    v_pk_mul_f32 v[152:153], v[152:153], v[60:61]
    v_pk_mul_f32 v[154:155], v[154:155], v[62:63]
    v_pk_mul_f32 v[156:157], v[156:157], v[92:93]
    v_pk_mul_f32 v[158:159], v[158:159], v[94:95]
    v_cvt_pk_bf16_f32 v164, v152, v153
    v_cvt_pk_bf16_f32 v165, v154, v155
    v_cvt_pk_bf16_f32 v166, v156, v157
    v_cvt_pk_bf16_f32 v167, v158, v159
    ds_write_b64 v188, v[164:165] offset:768
    ds_write_b64 v188, v[166:167] offset:896
    v_pk_fma_f32 v[64:65], v[64:65], v[236:237], v[232:233]
    v_pk_fma_f32 v[66:67], v[66:67], v[238:239], v[234:235]
    v_pk_fma_f32 v[96:97], v[96:97], v[236:237], v[232:233]
    v_pk_fma_f32 v[98:99], v[98:99], v[238:239], v[234:235]
    v_pk_mul_f32 v[152:153], v[64:65], v[64:65]
    v_pk_mul_f32 v[154:155], v[66:67], v[66:67]
    v_pk_mul_f32 v[156:157], v[96:97], v[96:97]
    v_pk_mul_f32 v[158:159], v[98:99], v[98:99]
    v_pk_fma_f32 v[152:153], v[152:153], v[142:143], v[140:141]
    v_pk_fma_f32 v[154:155], v[154:155], v[142:143], v[140:141]
    v_pk_fma_f32 v[156:157], v[156:157], v[142:143], v[140:141]
    v_pk_fma_f32 v[158:159], v[158:159], v[142:143], v[140:141]
    v_pk_mul_f32 v[152:153], v[152:153], v[64:65]
    v_pk_mul_f32 v[154:155], v[154:155], v[66:67]
    v_pk_mul_f32 v[156:157], v[156:157], v[96:97]
    v_pk_mul_f32 v[158:159], v[158:159], v[98:99]
    v_exp_f32 v152, v152
    v_exp_f32 v153, v153
    v_exp_f32 v154, v154
    v_exp_f32 v155, v155
    v_exp_f32 v156, v156
    v_exp_f32 v157, v157
    v_exp_f32 v158, v158
    v_exp_f32 v159, v159
    v_pk_add_f32 v[152:153], v[152:153], 1.0 op_sel_hi:[1,0]
    v_pk_add_f32 v[154:155], v[154:155], 1.0 op_sel_hi:[1,0]
    v_pk_add_f32 v[156:157], v[156:157], 1.0 op_sel_hi:[1,0]
    v_pk_add_f32 v[158:159], v[158:159], 1.0 op_sel_hi:[1,0]
    v_rcp_f32 v152, v152
    v_rcp_f32 v153, v153
    v_rcp_f32 v154, v154
    v_rcp_f32 v155, v155
    v_rcp_f32 v156, v156
    v_rcp_f32 v157, v157
    v_rcp_f32 v158, v158
    v_rcp_f32 v159, v159
    v_pk_mul_f32 v[152:153], v[152:153], v[64:65]
    v_pk_mul_f32 v[154:155], v[154:155], v[66:67]
    v_pk_mul_f32 v[156:157], v[156:157], v[96:97]
    v_pk_mul_f32 v[158:159], v[158:159], v[98:99]
    v_cvt_pk_bf16_f32 v160, v152, v153
    v_cvt_pk_bf16_f32 v161, v154, v155
    v_cvt_pk_bf16_f32 v162, v156, v157
    v_cvt_pk_bf16_f32 v163, v158, v159
    ds_write_b64 v188, v[160:161] offset:1024
    ds_write_b64 v188, v[162:163] offset:1152
    v_pk_fma_f32 v[68:69], v[68:69], v[236:237], v[232:233]
    v_pk_fma_f32 v[70:71], v[70:71], v[238:239], v[234:235]
    v_pk_fma_f32 v[100:101], v[100:101], v[236:237], v[232:233]
    v_pk_fma_f32 v[102:103], v[102:103], v[238:239], v[234:235]
    v_pk_mul_f32 v[152:153], v[68:69], v[68:69]
    v_pk_mul_f32 v[154:155], v[70:71], v[70:71]
    v_pk_mul_f32 v[156:157], v[100:101], v[100:101]
    v_pk_mul_f32 v[158:159], v[102:103], v[102:103]
    v_pk_fma_f32 v[152:153], v[152:153], v[142:143], v[140:141]
    v_pk_fma_f32 v[154:155], v[154:155], v[142:143], v[140:141]
    v_pk_fma_f32 v[156:157], v[156:157], v[142:143], v[140:141]
    v_pk_fma_f32 v[158:159], v[158:159], v[142:143], v[140:141]
    v_pk_mul_f32 v[152:153], v[152:153], v[68:69]
    v_pk_mul_f32 v[154:155], v[154:155], v[70:71]
    v_pk_mul_f32 v[156:157], v[156:157], v[100:101]
    v_pk_mul_f32 v[158:159], v[158:159], v[102:103]
    v_exp_f32 v152, v152
    v_exp_f32 v153, v153
    v_exp_f32 v154, v154
    v_exp_f32 v155, v155
    v_exp_f32 v156, v156
    v_exp_f32 v157, v157
    v_exp_f32 v158, v158
    v_exp_f32 v159, v159
    v_pk_add_f32 v[152:153], v[152:153], 1.0 op_sel_hi:[1,0]
    v_pk_add_f32 v[154:155], v[154:155], 1.0 op_sel_hi:[1,0]
    v_pk_add_f32 v[156:157], v[156:157], 1.0 op_sel_hi:[1,0]
    v_pk_add_f32 v[158:159], v[158:159], 1.0 op_sel_hi:[1,0]
    v_rcp_f32 v152, v152
    v_rcp_f32 v153, v153
    v_rcp_f32 v154, v154
    v_rcp_f32 v155, v155
    v_rcp_f32 v156, v156
    v_rcp_f32 v157, v157
    v_rcp_f32 v158, v158
    v_rcp_f32 v159, v159
    v_pk_mul_f32 v[152:153], v[152:153], v[68:69]
    v_pk_mul_f32 v[154:155], v[154:155], v[70:71]
    v_pk_mul_f32 v[156:157], v[156:157], v[100:101]
    v_pk_mul_f32 v[158:159], v[158:159], v[102:103]
    v_cvt_pk_bf16_f32 v164, v152, v153
    v_cvt_pk_bf16_f32 v165, v154, v155
    v_cvt_pk_bf16_f32 v166, v156, v157
    v_cvt_pk_bf16_f32 v167, v158, v159
    ds_write_b64 v188, v[164:165] offset:1280
    ds_write_b64 v188, v[166:167] offset:1408
    v_pk_fma_f32 v[72:73], v[72:73], v[236:237], v[232:233]
    v_pk_fma_f32 v[74:75], v[74:75], v[238:239], v[234:235]
    v_pk_fma_f32 v[104:105], v[104:105], v[236:237], v[232:233]
    v_pk_fma_f32 v[106:107], v[106:107], v[238:239], v[234:235]
    v_pk_mul_f32 v[152:153], v[72:73], v[72:73]
    v_pk_mul_f32 v[154:155], v[74:75], v[74:75]
    v_pk_mul_f32 v[156:157], v[104:105], v[104:105]
    v_pk_mul_f32 v[158:159], v[106:107], v[106:107]
    v_pk_fma_f32 v[152:153], v[152:153], v[142:143], v[140:141]
    v_pk_fma_f32 v[154:155], v[154:155], v[142:143], v[140:141]
    v_pk_fma_f32 v[156:157], v[156:157], v[142:143], v[140:141]
    v_pk_fma_f32 v[158:159], v[158:159], v[142:143], v[140:141]
    v_pk_mul_f32 v[152:153], v[152:153], v[72:73]
    v_pk_mul_f32 v[154:155], v[154:155], v[74:75]
    v_pk_mul_f32 v[156:157], v[156:157], v[104:105]
    v_pk_mul_f32 v[158:159], v[158:159], v[106:107]
    v_exp_f32 v152, v152
    v_exp_f32 v153, v153
    v_exp_f32 v154, v154
    v_exp_f32 v155, v155
    v_exp_f32 v156, v156
    v_exp_f32 v157, v157
    v_exp_f32 v158, v158
    v_exp_f32 v159, v159
    s_waitcnt lgkmcnt(0)
    s_barrier
L_seg1:
    ds_read_b128 v[200:203], v189 offset:0
    ds_read_b128 v[204:207], v189 offset:4128
    ds_read_b128 v[208:211], v189 offset:512
    ds_read_b128 v[212:215], v189 offset:4640
    ds_read_b128 v[216:219], v189 offset:1024
    ds_read_b128 v[220:223], v189 offset:5152
    v_pk_add_f32 v[152:153], v[152:153], 1.0 op_sel_hi:[1,0]
    v_pk_add_f32 v[154:155], v[154:155], 1.0 op_sel_hi:[1,0]
    v_pk_add_f32 v[156:157], v[156:157], 1.0 op_sel_hi:[1,0]
    v_pk_add_f32 v[158:159], v[158:159], 1.0 op_sel_hi:[1,0]
    v_rcp_f32 v152, v152
    v_rcp_f32 v153, v153
    v_rcp_f32 v154, v154
    v_rcp_f32 v155, v155
    v_rcp_f32 v156, v156
    v_rcp_f32 v157, v157
    v_rcp_f32 v158, v158
    v_rcp_f32 v159, v159
    v_pk_mul_f32 v[152:153], v[152:153], v[72:73]
    v_pk_mul_f32 v[154:155], v[154:155], v[74:75]
    v_pk_mul_f32 v[156:157], v[156:157], v[104:105]
    v_pk_mul_f32 v[158:159], v[158:159], v[106:107]
    v_cvt_pk_bf16_f32 v160, v152, v153
    v_cvt_pk_bf16_f32 v161, v154, v155
    v_cvt_pk_bf16_f32 v162, v156, v157
    v_cvt_pk_bf16_f32 v163, v158, v159
    ds_write_b64 v188, v[160:161] offset:1536
    ds_write_b64 v188, v[162:163] offset:1664
    v_pk_fma_f32 v[76:77], v[76:77], v[236:237], v[232:233]
    v_pk_fma_f32 v[78:79], v[78:79], v[238:239], v[234:235]
    v_pk_fma_f32 v[108:109], v[108:109], v[236:237], v[232:233]
    v_pk_fma_f32 v[110:111], v[110:111], v[238:239], v[234:235]
    s_waitcnt lgkmcnt(7)
    buffer_store_dwordx4 v[200:203], v190, s[8:11], 0 offen offset:0 nt
    v_pk_mul_f32 v[152:153], v[76:77], v[76:77]
    v_pk_mul_f32 v[154:155], v[78:79], v[78:79]
    v_pk_mul_f32 v[156:157], v[108:109], v[108:109]
    v_pk_mul_f32 v[158:159], v[110:111], v[110:111]
    v_pk_fma_f32 v[152:153], v[152:153], v[142:143], v[140:141]
    v_pk_fma_f32 v[154:155], v[154:155], v[142:143], v[140:141]
    s_waitcnt lgkmcnt(6)
    buffer_store_dwordx4 v[204:207], v192, s[8:11], 0 offen offset:0 nt
    v_pk_fma_f32 v[156:157], v[156:157], v[142:143], v[140:141]
    v_pk_fma_f32 v[158:159], v[158:159], v[142:143], v[140:141]
    v_pk_mul_f32 v[152:153], v[152:153], v[76:77]
    v_pk_mul_f32 v[154:155], v[154:155], v[78:79]
    v_pk_mul_f32 v[156:157], v[156:157], v[108:109]
    v_pk_mul_f32 v[158:159], v[158:159], v[110:111]
    s_waitcnt lgkmcnt(5)
    buffer_store_dwordx4 v[208:211], v190, s[8:11], 0 offen offset:2048 nt
    v_exp_f32 v152, v152
    v_exp_f32 v153, v153
    v_exp_f32 v154, v154
    v_exp_f32 v155, v155
    v_exp_f32 v156, v156
    v_exp_f32 v157, v157
    s_waitcnt lgkmcnt(4)
    buffer_store_dwordx4 v[212:215], v192, s[8:11], 0 offen offset:2048 nt
    v_exp_f32 v158, v158
    v_exp_f32 v159, v159
    v_pk_add_f32 v[152:153], v[152:153], 1.0 op_sel_hi:[1,0]
    v_pk_add_f32 v[154:155], v[154:155], 1.0 op_sel_hi:[1,0]
    v_pk_add_f32 v[156:157], v[156:157], 1.0 op_sel_hi:[1,0]
    v_pk_add_f32 v[158:159], v[158:159], 1.0 op_sel_hi:[1,0]
    s_waitcnt lgkmcnt(3)
    buffer_store_dwordx4 v[216:219], v191, s[8:11], 0 offen offset:0 nt
    v_rcp_f32 v152, v152
    v_rcp_f32 v153, v153
    v_rcp_f32 v154, v154
    v_rcp_f32 v155, v155
    v_rcp_f32 v156, v156
    v_rcp_f32 v157, v157
    s_waitcnt lgkmcnt(2)
    buffer_store_dwordx4 v[220:223], v193, s[8:11], 0 offen offset:0 nt
    v_rcp_f32 v158, v158
    v_rcp_f32 v159, v159
    v_pk_mul_f32 v[152:153], v[152:153], v[76:77]
    v_pk_mul_f32 v[154:155], v[154:155], v[78:79]
    v_pk_mul_f32 v[156:157], v[156:157], v[108:109]
    v_pk_mul_f32 v[158:159], v[158:159], v[110:111]
    v_cvt_pk_bf16_f32 v164, v152, v153
    v_cvt_pk_bf16_f32 v165, v154, v155
    v_cvt_pk_bf16_f32 v166, v156, v157
    v_cvt_pk_bf16_f32 v167, v158, v159
    ds_write_b64 v188, v[164:165] offset:1792
    ds_write_b64 v188, v[166:167] offset:1920
    s_waitcnt lgkmcnt(0)
    s_barrier
L_seg2:
    ds_read_b128 v[224:227], v189 offset:1536
    ds_read_b128 v[228:231], v189 offset:5664
    s_waitcnt lgkmcnt(1)
    buffer_store_dwordx4 v[224:227], v191, s[8:11], 0 offen offset:2048 nt
    s_waitcnt lgkmcnt(0)
    buffer_store_dwordx4 v[228:231], v194, s[8:11], 0 offen offset:2048 nt
L_end:
    s_endpgm
L_spinA:
    s_mov_b32 s52, 30000
L_spinA1:
    buffer_load_dwordx2 v[150:151], v149, s[32:35], 0 offen offset:0 sc1
    s_sub_u32 s52, s52, 1
    s_cbranch_scc1 L_spinA_ret
    s_waitcnt vmcnt(0)
    v_cmp_eq_u32 vcc, s41, v150
    v_cmp_eq_u32 s[50:51], s42, v151
    s_nop 3
    s_and_b64 vcc, vcc, s[50:51]
    s_andn2_b64 vcc, 0xff, vcc
    s_cbranch_scc1 L_spinA1
    s_branch L_spinA_ret
L_spinB:
    s_mov_b32 s52, 30000
L_spinB1:
    buffer_load_dwordx2 v[150:151], v149, s[32:35], 0 offen offset:0 sc1
    s_sub_u32 s52, s52, 1
    s_cbranch_scc1 L_spinB_ret
    s_waitcnt vmcnt(0)
    v_cmp_eq_u32 vcc, s41, v150
    v_cmp_eq_u32 s[50:51], s42, v151
    s_nop 3
    s_and_b64 vcc, vcc, s[50:51]
    s_andn2_b64 vcc, -1, vcc
    s_cbranch_scc1 L_spinB1
    s_branch L_spinB_ret
L_codeend:
.section .rodata,"a"
.p2align 6
.amdhsa_kernel standalone__self_sup_conv_stem_hubert__speech_kernel
.amdhsa_next_free_vgpr 512
.amdhsa_next_free_sgpr 102
.amdhsa_accum_offset 256
.amdhsa_group_segment_fixed_size 0
.amdhsa_kernarg_size 64
.amdhsa_user_sgpr_count 2
.amdhsa_user_sgpr_kernarg_segment_ptr 1
.amdhsa_system_sgpr_workgroup_id_x 1
.end_amdhsa_kernel
```
